```python
import torch

def _softmax(x, axis=-1):
    return torch.softmax(x, dim=axis)
def _gelu(x):
    return torch.nn.functional.gelu(x, approximate="tanh")
def _silu(x):
    return torch.nn.functional.silu(x)
def _sigmoid(x):
    return torch.sigmoid(x)
def _layernorm(x, axis=-1, eps=1e-5):
    m = x.mean(dim=axis, keepdim=True)
    v = x.var(dim=axis, keepdim=True, unbiased=False)
    return (x - m) / torch.sqrt(v + eps)
def _scatter_add(tgt, idx, src, axis=0):
    return tgt.clone().index_add_(axis, idx, src)
def _segment_sum(src, seg, n):
    out = torch.zeros((n,) + src.shape[1:], dtype=src.dtype)
    return out.index_add_(0, seg, src)
def _pad(x, pw):
    flat = tuple(v for pair in reversed(pw) for v in pair)
    return torch.nn.functional.pad(x, flat)

kernel_name = 'recurrent_scan__linear_attn_block__swiglu_ffn__prompt'

def setup_inputs():

    _w = (lambda a: (lambda t: t.to(torch.bfloat16) if t.is_floating_point() else t)(torch.as_tensor(a)))
    def _A_setup():
        B, S, D = 1, 2048, 448
        return {
            "x": _w((lambda *s: torch.randn(*s, dtype=torch.bfloat16) * 0.05)(B, S, D)),
            "wqkv": _w((lambda *s: torch.randn(*s, dtype=torch.bfloat16) * 0.05)(D, 3 * D)),
            "wo": _w((lambda *s: torch.randn(*s, dtype=torch.bfloat16) * 0.05)(D, D)),
        }
    _A_in = _A_setup()

    def _B_setup():
        B, S, D, F = 1, 2048, 448, 1792
        return {
            "x": _w((lambda *s: torch.randn(*s, dtype=torch.bfloat16) * 0.05)(B, S, D)),
            "w_gate": _w((lambda *s: torch.randn(*s, dtype=torch.bfloat16) * 0.05)(D, F)),
            "w_up": _w((lambda *s: torch.randn(*s, dtype=torch.bfloat16) * 0.05)(D, F)),
            "w_down": _w((lambda *s: torch.randn(*s, dtype=torch.bfloat16) * 0.05)(F, D)),
        }
    _B_in = _B_setup()

    return {
        "A_x": _A_in["x"],
        "A_wqkv": _A_in["wqkv"],
        "A_wo": _A_in["wo"],
        "B_x": _B_in["x"],
        "B_w_gate": _B_in["w_gate"],
        "B_w_up": _B_in["w_up"],
        "B_w_down": _B_in["w_down"],
    }

def reference(A_x, A_wqkv, A_wo, B_x, B_w_gate, B_w_up, B_w_down):
    def _A_ref(x, wqkv, wo):
        B, S, D = x.shape
        H = 16; Dh = D // H
        qkv = (lambda x, *d: x.permute(*d))((x @ wqkv).reshape(B, S, 3, H, Dh), 2, 0, 3, 1, 4)
        q, k, v = qkv[0], qkv[1], qkv[2]
        phi = lambda t: torch.where(t > 0, t + 1, torch.exp(t)) + 1e-6
        pq, pk = phi(q), phi(k)
        kv = torch.einsum("bhsd,bhse->bhde", pk, v)
        z = torch.einsum("bhsd->bhd", pk)
        num = torch.einsum("bhqd,bhde->bhqe", pq, kv)
        den = torch.einsum("bhqd,bhd->bhq", pq, z)[..., None] + 1e-6
        o = num / den
        return (lambda x, *d: x.permute(*d))(o, 0, 2, 1, 3).reshape(B, S, D) @ wo

    def _B_ref(x, w_gate, w_up, w_down):
        g = _silu(x @ w_gate)
        u = x @ w_up
        return (g * u) @ w_down

    x = A_x
    xn = _layernorm(x, axis=-1)
    s = _A_ref(xn, A_wqkv, A_wo)
    g = _silu(_B_ref(xn, B_w_gate, B_w_up, B_w_down))
    return x + s * g
```

```asm
; @launch grid=(256,1,1) block=(512,1,1) lds=163840
.amdgcn_target "amdgcn-amd-amdhsa--gfx950"
.text
.globl recurrent_scan__linear_attn_block__swiglu_ffn__prompt_kernel
.p2align 8
.type recurrent_scan__linear_attn_block__swiglu_ffn__prompt_kernel,@function
recurrent_scan__linear_attn_block__swiglu_ffn__prompt_kernel:
    s_cmp_ge_u32 s2, 256
    s_cbranch_scc1 L_end
    s_load_dwordx4 s[4:7], s[0:1], 0
    s_load_dwordx4 s[40:43], s[0:1], 32
    s_load_dwordx2 s[8:9], s[0:1], 72
    s_load_dwordx2 s[10:11], s[0:1], 64
    s_load_dwordx2 s[68:69], s[0:1], 16
    s_load_dwordx4 s[64:67], s[0:1], 48
    v_and_b32 v226, 63, v0
    v_lshrrev_b32 v192, 6, v0
    s_and_b32 s29, s2, 7
    s_lshr_b32 s30, s2, 3
    v_readfirstlane_b32 s24, v192
    s_and_b32 s71, s30, 7
    s_lshr_b32 s32, s30, 3
    s_lshl_b32 s70, s29, 2
    s_add_u32 s70, s70, s32
    s_lshr_b32 s31, s29, 1
    s_lshl_b32 s31, s31, 2
    s_add_u32 s27, s31, s32
    s_and_b32 s31, s29, 1
    s_mul_i32 s28, s31, 7
    s_add_u32 s28, s28, s71
    s_add_u32 s33, s31, 14
    s_cmp_eq_u32 s71, 7
    s_cselect_b32 s28, s33, s28
    s_lshl_b32 s93, s32, 1
    s_add_u32 s93, s93, s71
    s_mul_hi_u32 s31, s93, 613566757
    s_mul_i32 s31, s31, 7
    s_sub_u32 s93, s93, s31
    v_lshrrev_b32 v192, 3, v226
    v_and_b32 v193, 7, v226
    v_lshrrev_b32 v194, 4, v226
    v_xor_b32 v195, v193, v194
    v_mul_u32_u24 v196, 896, v192
    v_lshl_add_u32 v224, v195, 4, v196
    v_xor_b32 v195, 4, v195
    v_lshl_add_u32 v225, v195, 4, v196
    v_add_u32 v225, 7168, v225
    s_waitcnt lgkmcnt(0)
    s_mov_b32 s12, s4
    s_and_b32 s13, s5, 0xffff
    s_mov_b32 s14, 1835008
    s_mov_b32 s15, 0x20000
    s_mov_b32 s44, s8
    s_and_b32 s45, s9, 0xffff
    s_mov_b32 s46, 16777216
    s_mov_b32 s47, 0x20000
    s_cmp_ge_u32 s2, 8
    s_cbranch_scc1 L_g1_noinit_1
    v_mov_b32 v248, 0
    v_mov_b32 v249, 0
    v_mov_b32 v250, 0
    v_mov_b32 v251, 0
    s_mul_i32 s29, s2, 12288
    s_mul_i32 s30, s24, 1536
    s_add_u32 s29, s29, s30
    v_lshlrev_b32 v246, 4, v226
    v_add_u32 v246, s29, v246
    buffer_store_dwordx4 v[248:251], v246, s[44:47], 0 offen sc1
    s_mov_b32 exec_hi, 0
    buffer_store_dwordx4 v[248:251], v246, s[44:47], 0 offen offset:1024 sc1
    s_mov_b64 exec, -1
L_g1_noinit_1:
    s_lshl_b32 s29, s27, 7
    s_lshl_b32 s30, s24, 4
    s_add_u32 s29, s29, s30
    s_mul_i32 s8, s29, 896
    s_lshl_b32 s61, s24, 11
    s_lshl_b32 s62, s24, 10
    s_lshl_b32 s29, s93, 7
    s_add_u32 s72, s29, s8
    s_add_u32 m0, s61, 0
    s_nop 0
    buffer_load_dwordx4 v224, s[12:15], s72 offen lds
    s_add_u32 m0, s61, 1024
    s_nop 0
    buffer_load_dwordx4 v225, s[12:15], s72 offen lds
    s_add_u32 m0, s62, 49152
    s_lshr_b32 s25, s24, 2
    s_and_b32 s26, s24, 3
    s_mov_b32 s36, 3584
    s_mov_b32 s18, 1605632
    s_cmp_ge_u32 s28, 14
    s_cselect_b32 s34, 1, 0
    s_cselect_b32 s36, 2688, s36
    s_cselect_b32 s16, s6, s40
    s_cselect_b32 s17, s7, s41
    s_cselect_b32 s18, 1204224, s18
    s_cselect_b32 s20, s6, s42
    s_cselect_b32 s21, s7, s43
    s_mov_b32 s22, s18
    s_and_b32 s17, s17, 0xffff
    s_and_b32 s21, s21, 0xffff
    s_mov_b32 s19, 0x20000
    s_mov_b32 s23, 0x20000
    s_cmp_eq_u32 s28, 15
    s_cselect_b32 s35, 8, 0
    s_lshl_b32 s37, s36, 6
    s_mov_b32 s48, s6
    s_and_b32 s49, s7, 0xffff
    s_mov_b32 s50, 1204224
    s_mov_b32 s51, 0x20000
    s_mov_b32 s52, s10
    s_and_b32 s53, s11, 0xffff
    s_mov_b32 s54, 256
    s_mov_b32 s55, 0x20000
    s_mov_b32 s10, s8
    s_and_b32 s29, s24, 3
    s_mul_i32 s29, s29, 43008
    s_mov_b32 s30, 1792
    s_cmp_lt_u32 s24, 4
    s_cselect_b32 s30, 896, s30
    s_add_u32 s29, s29, s30
    s_mul_i32 s30, s28, 56
    s_add_u32 s29, s29, s30
    s_sub_u32 s33, s29, s35
    s_lshl_b32 s31, s28, 8
    s_add_u32 s32, s31, 128
    s_cmp_eq_u32 s28, 14
    s_cselect_b32 s31, 0, s31
    s_cselect_b32 s32, 224, s32
    s_cmp_eq_u32 s28, 15
    s_cselect_b32 s31, 448, s31
    s_cselect_b32 s32, 640, s32
    s_sub_u32 s39, s32, s31
    s_lshl_b32 s29, s24, 3
    s_mul_i32 s29, s29, s36
    s_add_u32 s11, s29, s31
    s_lshl_b32 s29, s93, 7
    s_add_u32 s72, s29, s10
    s_mul_i32 s29, s93, s37
    s_add_u32 s79, s29, s11
    s_mul_i32 s29, s93, 172032
    s_add_u32 s86, s29, s33
    s_add_u32 s93, s93, 1
    s_cmp_eq_u32 s93, 7
    s_cselect_b32 s93, 0, s93
    s_mov_b32 s41, s31
    s_cmp_eq_u32 s34, 1
    s_cselect_b32 s42, s32, s31
    v_and_b32 v194, 1, v194
    v_lshlrev_b32 v194, 2, v194
    v_xor_b32 v193, v193, v194
    v_mul_lo_u32 v196, v192, s36
    v_lshl_add_u32 v229, v193, 4, v196
    s_xor_b32 s29, s34, 1
    s_lshl_b32 s29, s29, 1
    v_xor_b32 v193, s29, v193
    v_lshl_add_u32 v230, v193, 4, v196
    s_lshl_b32 s29, s34, 7
    v_add_u32 v230, s29, v230
    v_lshrrev_b32 v192, 2, v226
    v_and_b32 v193, 3, v226
    v_mul_u32_u24 v192, 2688, v192
    v_lshl_add_u32 v223, v193, 4, v192
    s_mov_b32 s3, 0xffff0000
    buffer_load_dwordx4 v229, s[16:19], s79 offen lds
    s_add_u32 m0, s62, 57344
    s_nop 0
    buffer_load_dwordx4 v230, s[20:23], s79 offen lds
    s_add_u32 m0, s62, 98304
    s_nop 0
    buffer_load_dwordx4 v223, s[48:51], s86 offen lds
    s_cmp_ge_u32 s2, 8
    s_cbranch_scc1 L_g1_nogo_2
    s_waitcnt vmcnt(5)
    s_barrier
    s_cmp_lg_u32 s24, 0
    s_cbranch_scc1 L_g1_nogo_2
    v_mov_b32 v246, 0
    v_mov_b32 v247, 1
    v_cmp_eq_u32 vcc, 0, v226
    s_and_saveexec_b64 s[30:31], vcc
    buffer_atomic_add v247, v246, s[52:55], 0 offen
    s_mov_b64 exec, s[30:31]
L_g1_nogo_2:
    v_lshlrev_b32 v186, 4, v226
    v_lshlrev_b32 v187, 2, v226
    v_and_b32 v246, 15, v226
    v_lshlrev_b32 v246, 2, v246
    v_bfe_u32 v247, v226, 4, 1
    v_mul_u32_u24 v247, 896, v247
    v_add_u32 v246, v246, v247
    v_lshrrev_b32 v247, 5, v226
    v_mul_u32_u24 v247, 2688, v247
    v_add_u32 v188, v246, v247
    v_mov_b32 v172, 0
    v_mov_b32 v173, 0
    v_mov_b32 v174, 0
    v_mov_b32 v175, 0
    s_lshl_b32 s29, s27, 7
    s_lshl_b32 s30, s28, 3
    s_add_u32 s29, s29, s30
    s_add_u32 s29, s29, s24
    s_mul_i32 s56, s29, 896
    s_mul_i32 s29, s27, 28
    s_lshl_b32 s30, s24, 2
    s_add_u32 s29, s29, s30
    s_mul_i32 s30, s29, s36
    s_mul_i32 s59, s29, 2688
    s_cmp_eq_u32 s24, 7
    s_cselect_b32 s29, 0x40000000, 0
    s_add_u32 s30, s30, s29
    s_add_u32 s59, s59, s29
    s_add_u32 s57, s41, s30
    s_add_u32 s58, s42, s30
    s_mul_i32 s29, s28, 56
    s_sub_u32 s29, s29, s35
    s_add_u32 s29, s29, 896
    s_add_u32 s59, s59, s29
    s_mov_b32 exec_hi, 0x00ffffff
    buffer_load_dwordx4 v[172:175], v186, s[12:15], s56 offen
    s_mov_b64 exec, -1
    buffer_load_dword v176, v187, s[16:19], s57 offen
    buffer_load_dword v180, v187, s[20:23], s58 offen
    s_add_u32 s57, s57, s36
    s_add_u32 s58, s58, s36
    buffer_load_dword v177, v187, s[16:19], s57 offen
    buffer_load_dword v181, v187, s[20:23], s58 offen
    s_add_u32 s57, s57, s36
    s_add_u32 s58, s58, s36
    buffer_load_dword v178, v187, s[16:19], s57 offen
    buffer_load_dword v182, v187, s[20:23], s58 offen
    s_add_u32 s57, s57, s36
    s_add_u32 s58, s58, s36
    buffer_load_dword v179, v187, s[16:19], s57 offen
    buffer_load_dword v183, v187, s[20:23], s58 offen
    buffer_load_dword v184, v188, s[48:51], s59 offen
    s_add_u32 s59, s59, 5376
    buffer_load_dword v185, v188, s[48:51], s59 offen
    s_lshl_b32 s29, s93, 7
    s_add_u32 s73, s29, s10
    s_mul_i32 s29, s93, s37
    s_add_u32 s80, s29, s11
    s_mul_i32 s29, s93, 172032
    s_add_u32 s87, s29, s33
    s_add_u32 s93, s93, 1
    s_cmp_eq_u32 s93, 7
    s_cselect_b32 s93, 0, s93
    s_lshl_b32 s29, s93, 7
    s_add_u32 s74, s29, s10
    s_mul_i32 s29, s93, s37
    s_add_u32 s81, s29, s11
    s_mul_i32 s29, s93, 172032
    s_add_u32 s88, s29, s33
    s_add_u32 s93, s93, 1
    s_cmp_eq_u32 s93, 7
    s_cselect_b32 s93, 0, s93
    s_lshl_b32 s29, s93, 7
    s_add_u32 s75, s29, s10
    s_mul_i32 s29, s93, s37
    s_add_u32 s82, s29, s11
    s_mul_i32 s29, s93, 172032
    s_add_u32 s89, s29, s33
    s_add_u32 s93, s93, 1
    s_cmp_eq_u32 s93, 7
    s_cselect_b32 s93, 0, s93
    s_lshl_b32 s29, s93, 7
    s_add_u32 s76, s29, s10
    s_mul_i32 s29, s93, s37
    s_add_u32 s83, s29, s11
    s_mul_i32 s29, s93, 172032
    s_add_u32 s90, s29, s33
    s_add_u32 s93, s93, 1
    s_cmp_eq_u32 s93, 7
    s_cselect_b32 s93, 0, s93
    s_lshl_b32 s29, s93, 7
    s_add_u32 s77, s29, s10
    s_mul_i32 s29, s93, s37
    s_add_u32 s84, s29, s11
    s_mul_i32 s29, s93, 172032
    s_add_u32 s91, s29, s33
    s_add_u32 s93, s93, 1
    s_cmp_eq_u32 s93, 7
    s_cselect_b32 s93, 0, s93
    s_lshl_b32 s29, s93, 7
    s_add_u32 s78, s29, s10
    s_mul_i32 s29, s93, s37
    s_add_u32 s85, s29, s11
    s_mul_i32 s29, s93, 172032
    s_add_u32 s92, s29, s33
    s_add_u32 s93, s93, 1
    s_cmp_eq_u32 s93, 7
    s_cselect_b32 s93, 0, s93
    s_mov_b32 s63, 1065369472
    s_mov_b32 s33, 897988541
    s_mov_b32 s93, 1069066811
    v_and_b32 v192, 31, v226
    v_lshrrev_b32 v193, 5, v226
    v_bfe_u32 v194, v226, 1, 3
    v_xor_b32 v193, v193, v194
    v_lshlrev_b32 v192, 7, v192
    v_lshl_add_u32 v192, v193, 4, v192
    s_lshl_b32 s29, s26, 12
    v_add_u32 v216, s29, v192
    v_xor_b32 v217, 32, v216
    v_xor_b32 v218, 64, v216
    v_xor_b32 v219, 96, v216
    v_lshrrev_b32 v192, 5, v226
    v_lshlrev_b32 v192, 3, v192
    v_bfe_u32 v193, v226, 2, 2
    v_add_u32 v192, v192, v193
    v_and_b32 v193, 3, v226
    v_lshlrev_b32 v193, 3, v193
    v_bfe_u32 v194, v226, 4, 1
    v_bfe_u32 v195, v226, 3, 1
    v_lshlrev_b32 v195, 6, v195
    s_cmp_eq_u32 s34, 1
    s_cbranch_scc1 L_g1_setA_4
    v_lshlrev_b32 v196, 13, v194
    v_lshl_add_u32 v196, v192, 7, v196
    v_lshl_add_u32 v197, v194, 5, v193
    v_xor_b32 v197, v197, v195
    v_add_u32 v196, 49152, v196
    v_xor_b32 v198, 0, v197
    v_add_u32 v200, v196, v198
    v_mov_b32 v204, v200
    v_xor_b32 v198, 32, v197
    v_add_u32 v201, v196, v198
    v_mov_b32 v205, v201
    v_xor_b32 v198, 64, v197
    v_add_u32 v202, v196, v198
    v_mov_b32 v206, v202
    v_xor_b32 v198, 96, v197
    v_add_u32 v203, v196, v198
    v_mov_b32 v207, v203
    s_branch L_g1_setD_5
L_g1_setA_4:
    v_lshl_add_u32 v196, v194, 5, v193
    v_lshlrev_b32 v197, 7, v192
    v_add_u32 v197, 49152, v197
    s_cmp_eq_u32 s28, 15
    s_cselect_b32 s29, 32, 0
    s_cselect_b32 s30, 24, 0
    v_add_u32 v198, 0, v196
    v_lshrrev_b32 v199, 7, v198
    v_and_b32 v198, 127, v198
    v_xor_b32 v198, v198, v195
    v_lshl_add_u32 v198, v199, 13, v198
    v_add_u32 v200, v197, v198
    v_add_u32 v198, 56, v196
    v_lshrrev_b32 v199, 7, v198
    v_and_b32 v198, 127, v198
    v_xor_b32 v198, v198, v195
    v_lshl_add_u32 v198, v199, 13, v198
    v_add_u32 v201, v197, v198
    v_add_u32 v198, 112, v196
    v_lshrrev_b32 v199, 7, v198
    v_and_b32 v198, 127, v198
    v_xor_b32 v198, v198, v195
    v_lshl_add_u32 v198, v199, 13, v198
    v_add_u32 v202, v197, v198
    v_add_u32 v198, 168, v196
    v_lshrrev_b32 v199, 7, v198
    v_and_b32 v198, 127, v198
    v_xor_b32 v198, v198, v195
    v_lshl_add_u32 v198, v199, 13, v198
    v_add_u32 v203, v197, v198
    s_add_u32 s31, s29, 0
    v_add_u32 v198, s31, v196
    v_lshrrev_b32 v199, 7, v198
    v_and_b32 v198, 127, v198
    v_xor_b32 v198, v198, v195
    v_lshl_add_u32 v198, v199, 13, v198
    v_add_u32 v204, v197, v198
    s_add_u32 s31, s29, 56
    v_add_u32 v198, s31, v196
    v_lshrrev_b32 v199, 7, v198
    v_and_b32 v198, 127, v198
    v_xor_b32 v198, v198, v195
    v_lshl_add_u32 v198, v199, 13, v198
    v_add_u32 v205, v197, v198
    s_add_u32 s31, s29, 112
    v_add_u32 v198, s31, v196
    v_lshrrev_b32 v199, 7, v198
    v_and_b32 v198, 127, v198
    v_xor_b32 v198, v198, v195
    v_lshl_add_u32 v198, v199, 13, v198
    v_add_u32 v206, v197, v198
    s_add_u32 s31, s30, 168
    v_add_u32 v198, s31, v196
    v_lshrrev_b32 v199, 7, v198
    v_and_b32 v198, 127, v198
    v_xor_b32 v198, v198, v195
    v_lshl_add_u32 v198, v199, 13, v198
    v_add_u32 v207, v197, v198
L_g1_setD_5:
    v_lshlrev_b32 v196, 6, v192
    v_lshl_add_u32 v196, v194, 5, v196
    v_add_u32 v196, v196, v193
    v_add_u32 v196, 98304, v196
    s_cmp_eq_u32 s25, 1
    s_cbranch_scc1 L_g1_sel_6
    v_mov_b32 v220, v196
    v_add_u32 v221, 4096, v196
    v_mov_b32 v222, v200
    v_mov_b32 v227, v204
    v_mov_b32 v228, v205
    s_branch L_g1_sel_7
L_g1_sel_6:
    v_mov_b32 v220, v201
    v_mov_b32 v221, v202
    v_mov_b32 v222, v203
    v_mov_b32 v227, v206
    v_mov_b32 v228, v207
L_g1_sel_7:
    s_lshl_b32 s29, s24, 8
    s_add_u32 s29, s29, 122880
    v_lshlrev_b32 v246, 2, v226
    v_add_u32 v238, s29, v246
    s_mul_i32 s29, s28, 1280
    s_lshl_b32 s30, s24, 8
    s_add_u32 s29, s29, s30
    s_add_u32 s29, s29, 65536
    s_cmp_ge_u32 s24, 5
    s_cselect_b32 s29, 0x40000000, s29
    v_add_u32 v239, s29, v246
    s_lshl_b32 s29, s27, 7
    s_lshl_b32 s30, s28, 3
    s_add_u32 s29, s29, s30
    s_add_u32 s29, s29, s24
    s_lshl_b32 s30, s29, 3
    s_add_u32 s30, s30, 131072
    v_cmp_eq_u32 vcc, 0, v226
    v_mov_b32 v248, 0x40000000
    v_mov_b32 v249, s30
    v_mov_b32 v241, 0
    v_cndmask_b32 v240, v248, v249, vcc
    s_add_u32 m0, s61, 16384
    s_nop 0
    buffer_load_dwordx4 v224, s[12:15], s73 offen lds
    s_add_u32 m0, s61, 17408
    s_nop 0
    buffer_load_dwordx4 v225, s[12:15], s73 offen lds
    s_add_u32 m0, s62, 65536
    s_nop 0
    buffer_load_dwordx4 v229, s[16:19], s80 offen lds
    s_add_u32 m0, s62, 73728
    s_nop 0
    buffer_load_dwordx4 v230, s[20:23], s80 offen lds
    s_add_u32 m0, s62, 106496
    s_nop 0
    buffer_load_dwordx4 v223, s[48:51], s87 offen lds
    s_waitcnt vmcnt(16)
    s_barrier
    s_cmp_eq_u32 s25, 1
    s_cbranch_scc1 L_g1_h1_8
    s_setprio 1
    ds_read_b128 v[0:3], v216 offset:0
    ds_read_b64_tr_b16 v[192:193], v220 offset:0
    ds_read_b64_tr_b16 v[194:195], v220 offset:256
    ds_read_b64_tr_b16 v[196:197], v221 offset:0
    ds_read_b64_tr_b16 v[198:199], v221 offset:256
    ds_read_b64_tr_b16 v[200:201], v222 offset:0
    ds_read_b64_tr_b16 v[202:203], v222 offset:512
    ds_read_b128 v[4:7], v217 offset:0
    ds_read_b64_tr_b16 v[204:205], v220 offset:1024
    ds_read_b64_tr_b16 v[206:207], v220 offset:1280
    ds_read_b64_tr_b16 v[208:209], v221 offset:1024
    ds_read_b64_tr_b16 v[210:211], v221 offset:1280
    ds_read_b64_tr_b16 v[212:213], v222 offset:2048
    ds_read_b64_tr_b16 v[214:215], v222 offset:2560
    s_waitcnt lgkmcnt(7)
    v_mfma_f32_32x32x16_bf16 v[112:127], v[0:3], v[192:195], 0
    ds_read_b128 v[8:11], v218 offset:0
    ds_read_b64_tr_b16 v[160:161], v220 offset:2048
    ds_read_b64_tr_b16 v[162:163], v220 offset:2304
    s_waitcnt vmcnt(5)
    v_lshlrev_b32 v186, 16, v176
    v_and_b32 v187, s3, v176
    v_lshlrev_b32 v188, 16, v180
    v_and_b32 v189, s3, v180
    v_lshlrev_b32 v246, 16, v177
    v_and_b32 v247, s3, v177
    v_add_f32 v186, v186, v246
    v_mfma_f32_32x32x16_bf16 v[128:143], v[0:3], v[196:199], 0
    ds_read_b64_tr_b16 v[164:165], v221 offset:2048
    ds_read_b64_tr_b16 v[166:167], v221 offset:2304
    ds_read_b64_tr_b16 v[168:169], v222 offset:4096
    v_add_f32 v187, v187, v247
    v_lshlrev_b32 v246, 16, v181
    v_and_b32 v247, s3, v181
    v_add_f32 v188, v188, v246
    v_add_f32 v189, v189, v247
    v_lshlrev_b32 v246, 16, v178
    v_and_b32 v247, s3, v178
    s_add_u32 m0, s61, 32768
    s_nop 0
    buffer_load_dwordx4 v224, s[12:15], s74 offen lds
    s_add_u32 m0, s61, 33792
    v_mfma_f32_32x32x16_bf16 v[144:159], v[200:203], v[0:3], 0
    ds_read_b64_tr_b16 v[170:171], v222 offset:4608
    v_add_f32 v186, v186, v246
    v_add_f32 v187, v187, v247
    v_lshlrev_b32 v246, 16, v182
    v_and_b32 v247, s3, v182
    v_add_f32 v188, v188, v246
    v_add_f32 v189, v189, v247
    v_lshlrev_b32 v246, 16, v179
    buffer_load_dwordx4 v225, s[12:15], s74 offen lds
    s_add_u32 m0, s62, 81920
    s_waitcnt lgkmcnt(7)
    v_mfma_f32_32x32x16_bf16 v[112:127], v[4:7], v[204:207], v[112:127]
    ds_read_b128 v[12:15], v219 offset:0
    ds_read_b64_tr_b16 v[192:193], v220 offset:3072
    ds_read_b64_tr_b16 v[194:195], v220 offset:3328
    v_and_b32 v247, s3, v179
    v_add_f32 v186, v186, v246
    v_add_f32 v187, v187, v247
    v_lshlrev_b32 v246, 16, v183
    v_and_b32 v247, s3, v183
    v_add_f32 v188, v188, v246
    v_add_f32 v189, v189, v247
    v_mfma_f32_32x32x16_bf16 v[128:143], v[4:7], v[208:211], v[128:143]
    ds_read_b64_tr_b16 v[196:197], v221 offset:3072
    ds_read_b64_tr_b16 v[198:199], v221 offset:3328
    ds_read_b64_tr_b16 v[200:201], v222 offset:6144
    v_lshlrev_b32 v190, 16, v184
    v_and_b32 v191, s3, v184
    v_lshlrev_b32 v246, 16, v185
    v_and_b32 v247, s3, v185
    v_add_f32 v190, v190, v246
    v_add_f32 v191, v191, v247
    v_mov_b32 v246, v190
    buffer_load_dwordx4 v229, s[16:19], s81 offen lds
    s_add_u32 m0, s62, 90112
    v_mfma_f32_32x32x16_bf16 v[144:159], v[212:215], v[4:7], v[144:159]
    ds_read_b64_tr_b16 v[202:203], v222 offset:6656
    v_mov_b32 v247, v191
    s_mul_i32 s29, s24, 1280
    s_add_u32 s29, s29, 122880
    v_permlane32_swap_b32 v190, v246
    v_permlane32_swap_b32 v191, v247
    v_lshlrev_b32 v248, 3, v226
    v_add_u32 v248, s29, v248
    v_add_f32 v190, v190, v246
    v_add_f32 v191, v191, v247
    buffer_load_dwordx4 v230, s[20:23], s81 offen lds
    s_add_u32 m0, s62, 114688
    s_waitcnt lgkmcnt(7)
    v_mfma_f32_32x32x16_bf16 v[112:127], v[8:11], v[160:163], v[112:127]
    v_and_b32 v249, 31, v226
    v_lshlrev_b32 v249, 3, v249
    v_add_u32 v249, s29, v249
    ds_write_b64 v248, v[186:187]
    ds_write_b64 v248, v[188:189] offset:512
    ds_write_b64 v249, v[190:191] offset:1024
    buffer_load_dword v251, v241, s[52:55], 0 offen sc1
    v_mfma_f32_32x32x16_bf16 v[128:143], v[8:11], v[164:167], v[128:143]
    buffer_load_dwordx4 v223, s[48:51], s88 offen lds
    s_waitcnt lgkmcnt(0)
    s_waitcnt vmcnt(6)
    s_barrier
    ds_read_b128 v[16:19], v216 offset:16384
    ds_read_b64_tr_b16 v[204:205], v220 offset:8192
    ds_read_b64_tr_b16 v[206:207], v220 offset:8448
    ds_read_b64_tr_b16 v[208:209], v221 offset:8192
    ds_read_b32 v176, v238 offset:0
    ds_read_b32 v177, v238 offset:1280
    ds_read_b32 v178, v238 offset:2560
    ds_read_b32 v179, v238 offset:3840
    ds_read_b32 v180, v238 offset:5120
    ds_read_b32 v181, v238 offset:6400
    v_mfma_f32_32x32x16_bf16 v[144:159], v[168:171], v[8:11], v[144:159]
    ds_read_b64_tr_b16 v[210:211], v221 offset:8448
    ds_read_b64_tr_b16 v[212:213], v222 offset:16384
    ds_read_b64_tr_b16 v[214:215], v222 offset:16896
    ds_read_b32 v182, v238 offset:7680
    ds_read_b32 v183, v238 offset:8960
    v_lshlrev_b32 v246, 16, v172
    v_and_b32 v247, s3, v172
    v_add_f32 v184, v246, v247
    v_mul_f32 v185, v246, v246
    v_mfma_f32_32x32x16_bf16 v[112:127], v[12:15], v[192:195], v[112:127]
    ds_read_b128 v[20:23], v217 offset:16384
    ds_read_b64_tr_b16 v[160:161], v220 offset:9216
    ds_read_b64_tr_b16 v[162:163], v220 offset:9472
    v_fmac_f32 v185, v247, v247
    v_lshlrev_b32 v246, 16, v173
    v_and_b32 v247, s3, v173
    v_add_f32 v184, v184, v246
    v_fmac_f32 v185, v246, v246
    v_add_f32 v184, v184, v247
    v_mfma_f32_32x32x16_bf16 v[128:143], v[12:15], v[196:199], v[128:143]
    ds_read_b64_tr_b16 v[164:165], v221 offset:9216
    ds_read_b64_tr_b16 v[166:167], v221 offset:9472
    ds_read_b64_tr_b16 v[168:169], v222 offset:18432
    v_fmac_f32 v185, v247, v247
    v_lshlrev_b32 v246, 16, v174
    v_and_b32 v247, s3, v174
    v_add_f32 v184, v184, v246
    v_fmac_f32 v185, v246, v246
    v_add_f32 v184, v184, v247
    s_add_u32 m0, s61, 0
    s_nop 0
    buffer_load_dwordx4 v224, s[12:15], s75 offen lds
    s_add_u32 m0, s61, 1024
    v_mfma_f32_32x32x16_bf16 v[144:159], v[200:203], v[12:15], v[144:159]
    ds_read_b64_tr_b16 v[170:171], v222 offset:18944
    v_fmac_f32 v185, v247, v247
    v_lshlrev_b32 v246, 16, v175
    v_and_b32 v247, s3, v175
    v_add_f32 v184, v184, v246
    v_fmac_f32 v185, v246, v246
    v_add_f32 v184, v184, v247
    buffer_load_dwordx4 v225, s[12:15], s75 offen lds
    s_add_u32 m0, s62, 49152
    s_waitcnt lgkmcnt(9)
    v_mfma_f32_32x32x16_bf16 v[112:127], v[16:19], v[204:207], v[112:127]
    ds_read_b128 v[24:27], v218 offset:16384
    ds_read_b64_tr_b16 v[192:193], v220 offset:10240
    ds_read_b64_tr_b16 v[194:195], v220 offset:10496
    v_fmac_f32 v185, v247, v247
    s_nop 0
    v_add_f32_dpp v184, v184, v184 row_shr:1 row_mask:0xf bank_mask:0xf bound_ctrl:0
    v_add_f32_dpp v185, v185, v185 row_shr:1 row_mask:0xf bank_mask:0xf bound_ctrl:0
    s_nop 0
    v_add_f32_dpp v184, v184, v184 row_shr:2 row_mask:0xf bank_mask:0xf bound_ctrl:0
    v_add_f32_dpp v185, v185, v185 row_shr:2 row_mask:0xf bank_mask:0xf bound_ctrl:0
    s_nop 0
    v_add_f32_dpp v184, v184, v184 row_shr:4 row_mask:0xf bank_mask:0xf bound_ctrl:0
    v_mfma_f32_32x32x16_bf16 v[128:143], v[16:19], v[208:211], v[128:143]
    ds_read_b64_tr_b16 v[196:197], v221 offset:10240
    ds_read_b64_tr_b16 v[198:199], v221 offset:10496
    ds_read_b64_tr_b16 v[200:201], v222 offset:20480
    v_add_f32_dpp v185, v185, v185 row_shr:4 row_mask:0xf bank_mask:0xf bound_ctrl:0
    s_nop 0
    v_add_f32_dpp v184, v184, v184 row_shr:8 row_mask:0xf bank_mask:0xf bound_ctrl:0
    v_add_f32_dpp v185, v185, v185 row_shr:8 row_mask:0xf bank_mask:0xf bound_ctrl:0
    s_nop 0
    v_add_f32_dpp v184, v184, v184 row_bcast:15 row_mask:0xa bank_mask:0xf
    v_add_f32_dpp v185, v185, v185 row_bcast:15 row_mask:0xa bank_mask:0xf
    s_nop 0
    v_add_f32_dpp v184, v184, v184 row_bcast:31 row_mask:0xc bank_mask:0xf
    buffer_load_dwordx4 v229, s[16:19], s82 offen lds
    s_add_u32 m0, s62, 57344
    v_mfma_f32_32x32x16_bf16 v[144:159], v[212:215], v[16:19], v[144:159]
    ds_read_b64_tr_b16 v[202:203], v222 offset:20992
    v_add_f32_dpp v185, v185, v185 row_bcast:31 row_mask:0xc bank_mask:0xf
    s_nop 0
    v_readlane_b32 s29, v184, 63
    v_readlane_b32 s30, v185, 63
    v_mov_b32 v250, 991054117
    s_nop 0
    v_mul_f32 v184, s29, v250
    v_mul_f32 v185, s30, v250
    buffer_load_dwordx4 v230, s[20:23], s82 offen lds
    s_add_u32 m0, s62, 98304
    s_waitcnt lgkmcnt(7)
    v_mfma_f32_32x32x16_bf16 v[112:127], v[20:23], v[160:163], v[112:127]
    ds_read_b128 v[28:31], v219 offset:16384
    ds_read_b64_tr_b16 v[204:205], v220 offset:11264
    ds_read_b64_tr_b16 v[206:207], v220 offset:11520
    v_fma_f32 v185, -v184, v184, v185
    v_max_f32 v185, 0, v185
    v_cvt_pk_bf16_f32 v246, v185, v184
    v_lshlrev_b32 v247, 16, v246
    v_add_f32 v247, 925353388, v247
    v_cvt_pk_bf16_f32 v247, v247, v247
    v_mfma_f32_32x32x16_bf16 v[128:143], v[20:23], v[164:167], v[128:143]
    ds_read_b64_tr_b16 v[208:209], v221 offset:11264
    ds_read_b64_tr_b16 v[210:211], v221 offset:11520
    ds_read_b64_tr_b16 v[212:213], v222 offset:22528
    v_lshlrev_b32 v247, 16, v247
    v_sqrt_f32 v247, v247
    v_lshrrev_b32 v173, 16, v246
    v_cvt_pk_bf16_f32 v247, v247, v247
    v_lshlrev_b32 v172, 16, v247
    buffer_load_dwordx4 v223, s[48:51], s89 offen lds
    v_mfma_f32_32x32x16_bf16 v[144:159], v[168:171], v[20:23], v[144:159]
    ds_read_b64_tr_b16 v[214:215], v222 offset:23040
    v_add_f32 v176, v176, v177
    v_add_f32 v176, v176, v178
    v_add_f32 v176, v176, v179
    v_add_f32 v176, v176, v180
    v_add_f32 v176, v176, v181
    v_add_f32 v176, v176, v182
    s_waitcnt lgkmcnt(7)
    v_mfma_f32_32x32x16_bf16 v[112:127], v[24:27], v[192:195], v[112:127]
    v_add_f32 v176, v176, v183
    v_mfma_f32_32x32x16_bf16 v[128:143], v[24:27], v[196:199], v[128:143]
    s_waitcnt vmcnt(6)
    v_cmp_gt_u32 vcc, 8, v251
    s_nop 4
    s_cbranch_vccnz L_go_slow_11
L_go_back_12:
    buffer_atomic_add_f32 v176, v239, s[44:47], 0 offen
    buffer_store_dwordx2 v[172:173], v240, s[44:47], 0 offen sc1
    s_waitcnt lgkmcnt(0)
    s_waitcnt vmcnt(7)
    s_barrier
    ds_read_b128 v[32:35], v216 offset:32768
    ds_read_b64_tr_b16 v[160:161], v220 offset:16384
    ds_read_b64_tr_b16 v[162:163], v220 offset:16640
    ds_read_b64_tr_b16 v[164:165], v221 offset:16384
    v_mfma_f32_32x32x16_bf16 v[144:159], v[200:203], v[24:27], v[144:159]
    ds_read_b64_tr_b16 v[166:167], v221 offset:16640
    ds_read_b64_tr_b16 v[168:169], v222 offset:32768
    ds_read_b64_tr_b16 v[170:171], v222 offset:33280
    v_mfma_f32_32x32x16_bf16 v[112:127], v[28:31], v[204:207], v[112:127]
    ds_read_b128 v[36:39], v217 offset:32768
    ds_read_b64_tr_b16 v[192:193], v220 offset:17408
    ds_read_b64_tr_b16 v[194:195], v220 offset:17664
    v_mfma_f32_32x32x16_bf16 v[128:143], v[28:31], v[208:211], v[128:143]
    ds_read_b64_tr_b16 v[196:197], v221 offset:17408
    ds_read_b64_tr_b16 v[198:199], v221 offset:17664
    ds_read_b64_tr_b16 v[200:201], v222 offset:34816
    s_add_u32 m0, s61, 16384
    s_nop 0
    buffer_load_dwordx4 v224, s[12:15], s76 offen lds
    s_add_u32 m0, s61, 17408
    v_mfma_f32_32x32x16_bf16 v[144:159], v[212:215], v[28:31], v[144:159]
    ds_read_b64_tr_b16 v[202:203], v222 offset:35328
    buffer_load_dwordx4 v225, s[12:15], s76 offen lds
    s_add_u32 m0, s62, 65536
    s_waitcnt lgkmcnt(7)
    v_mfma_f32_32x32x16_bf16 v[112:127], v[32:35], v[160:163], v[112:127]
    ds_read_b128 v[40:43], v218 offset:32768
    ds_read_b64_tr_b16 v[204:205], v220 offset:18432
    ds_read_b64_tr_b16 v[206:207], v220 offset:18688
    v_mfma_f32_32x32x16_bf16 v[128:143], v[32:35], v[164:167], v[128:143]
    ds_read_b64_tr_b16 v[208:209], v221 offset:18432
    ds_read_b64_tr_b16 v[210:211], v221 offset:18688
    ds_read_b64_tr_b16 v[212:213], v222 offset:36864
    buffer_load_dwordx4 v229, s[16:19], s83 offen lds
    s_add_u32 m0, s62, 73728
    v_mfma_f32_32x32x16_bf16 v[144:159], v[168:171], v[32:35], v[144:159]
    ds_read_b64_tr_b16 v[214:215], v222 offset:37376
    buffer_load_dwordx4 v230, s[20:23], s83 offen lds
    s_add_u32 m0, s62, 106496
    s_waitcnt lgkmcnt(7)
    v_mfma_f32_32x32x16_bf16 v[112:127], v[36:39], v[192:195], v[112:127]
    ds_read_b128 v[44:47], v219 offset:32768
    ds_read_b64_tr_b16 v[160:161], v220 offset:19456
    ds_read_b64_tr_b16 v[162:163], v220 offset:19712
    v_mfma_f32_32x32x16_bf16 v[128:143], v[36:39], v[196:199], v[128:143]
    ds_read_b64_tr_b16 v[164:165], v221 offset:19456
    ds_read_b64_tr_b16 v[166:167], v221 offset:19712
    ds_read_b64_tr_b16 v[168:169], v222 offset:38912
    buffer_load_dwordx4 v223, s[48:51], s90 offen lds
    v_mfma_f32_32x32x16_bf16 v[144:159], v[200:203], v[36:39], v[144:159]
    ds_read_b64_tr_b16 v[170:171], v222 offset:39424
    s_waitcnt lgkmcnt(7)
    v_mfma_f32_32x32x16_bf16 v[112:127], v[40:43], v[204:207], v[112:127]
    v_mfma_f32_32x32x16_bf16 v[128:143], v[40:43], v[208:211], v[128:143]
    s_waitcnt vmcnt(5)
    s_waitcnt lgkmcnt(0)
    s_barrier
    ds_read_b128 v[48:51], v216 offset:0
    ds_read_b64_tr_b16 v[192:193], v220 offset:0
    ds_read_b64_tr_b16 v[194:195], v220 offset:256
    ds_read_b64_tr_b16 v[196:197], v221 offset:0
    v_mfma_f32_32x32x16_bf16 v[144:159], v[212:215], v[40:43], v[144:159]
    ds_read_b64_tr_b16 v[198:199], v221 offset:256
    ds_read_b64_tr_b16 v[200:201], v222 offset:0
    ds_read_b64_tr_b16 v[202:203], v222 offset:512
    s_cmp_lg_u32 s24, 0
    s_cbranch_scc1 L_presig_13
    s_add_u32 s29, s27, 48
    s_lshl_b32 s29, s29, 7
    s_add_u32 s29, s29, 86016
    v_mov_b32 v246, s29
    v_mov_b32 v247, 1
    v_cmp_eq_u32 vcc, 0, v226
    s_and_saveexec_b64 s[30:31], vcc
    buffer_atomic_add v247, v246, s[44:47], 0 offen
    s_mov_b64 exec, s[30:31]
    s_add_u32 s29, s28, 64
    s_lshl_b32 s29, s29, 7
    s_add_u32 s29, s29, 86016
    v_mov_b32 v246, s29
    v_mov_b32 v247, 1
    v_cmp_eq_u32 vcc, 0, v226
    s_and_saveexec_b64 s[30:31], vcc
    buffer_atomic_add v247, v246, s[44:47], 0 offen
    s_mov_b64 exec, s[30:31]
L_presig_13:
    v_mfma_f32_32x32x16_bf16 v[112:127], v[44:47], v[160:163], v[112:127]
    ds_read_b128 v[52:55], v217 offset:0
    ds_read_b64_tr_b16 v[204:205], v220 offset:1024
    ds_read_b64_tr_b16 v[206:207], v220 offset:1280
    v_mfma_f32_32x32x16_bf16 v[128:143], v[44:47], v[164:167], v[128:143]
    ds_read_b64_tr_b16 v[208:209], v221 offset:1024
    ds_read_b64_tr_b16 v[210:211], v221 offset:1280
    ds_read_b64_tr_b16 v[212:213], v222 offset:2048
    s_add_u32 m0, s61, 32768
    s_nop 0
    buffer_load_dwordx4 v224, s[12:15], s77 offen lds
    s_add_u32 m0, s61, 33792
    v_mfma_f32_32x32x16_bf16 v[144:159], v[168:171], v[44:47], v[144:159]
    ds_read_b64_tr_b16 v[214:215], v222 offset:2560
    buffer_load_dwordx4 v225, s[12:15], s77 offen lds
    s_add_u32 m0, s62, 81920
    s_waitcnt lgkmcnt(7)
    v_mfma_f32_32x32x16_bf16 v[112:127], v[48:51], v[192:195], v[112:127]
    ds_read_b128 v[56:59], v218 offset:0
    ds_read_b64_tr_b16 v[160:161], v220 offset:2048
    ds_read_b64_tr_b16 v[162:163], v220 offset:2304
    v_mfma_f32_32x32x16_bf16 v[128:143], v[48:51], v[196:199], v[128:143]
    ds_read_b64_tr_b16 v[164:165], v221 offset:2048
    ds_read_b64_tr_b16 v[166:167], v221 offset:2304
    ds_read_b64_tr_b16 v[168:169], v222 offset:4096
    buffer_load_dwordx4 v229, s[16:19], s84 offen lds
    s_add_u32 m0, s62, 90112
    v_mfma_f32_32x32x16_bf16 v[144:159], v[200:203], v[48:51], v[144:159]
    ds_read_b64_tr_b16 v[170:171], v222 offset:4608
    buffer_load_dwordx4 v230, s[20:23], s84 offen lds
    s_add_u32 m0, s62, 114688
    s_waitcnt lgkmcnt(7)
    v_mfma_f32_32x32x16_bf16 v[112:127], v[52:55], v[204:207], v[112:127]
    ds_read_b128 v[60:63], v219 offset:0
    ds_read_b64_tr_b16 v[192:193], v220 offset:3072
    ds_read_b64_tr_b16 v[194:195], v220 offset:3328
    v_mfma_f32_32x32x16_bf16 v[128:143], v[52:55], v[208:211], v[128:143]
    ds_read_b64_tr_b16 v[196:197], v221 offset:3072
    ds_read_b64_tr_b16 v[198:199], v221 offset:3328
    ds_read_b64_tr_b16 v[200:201], v222 offset:6144
    buffer_load_dwordx4 v223, s[48:51], s91 offen lds
    v_mfma_f32_32x32x16_bf16 v[144:159], v[212:215], v[52:55], v[144:159]
    ds_read_b64_tr_b16 v[202:203], v222 offset:6656
    s_waitcnt lgkmcnt(7)
    v_mfma_f32_32x32x16_bf16 v[112:127], v[56:59], v[160:163], v[112:127]
    v_mfma_f32_32x32x16_bf16 v[128:143], v[56:59], v[164:167], v[128:143]
    s_waitcnt lgkmcnt(0)
    s_waitcnt vmcnt(5)
    s_barrier
    ds_read_b128 v[64:67], v216 offset:16384
    ds_read_b64_tr_b16 v[204:205], v220 offset:8192
    ds_read_b64_tr_b16 v[206:207], v220 offset:8448
    ds_read_b64_tr_b16 v[208:209], v221 offset:8192
    v_mfma_f32_32x32x16_bf16 v[144:159], v[168:171], v[56:59], v[144:159]
    ds_read_b64_tr_b16 v[210:211], v221 offset:8448
    ds_read_b64_tr_b16 v[212:213], v222 offset:16384
    ds_read_b64_tr_b16 v[214:215], v222 offset:16896
    v_mfma_f32_32x32x16_bf16 v[112:127], v[60:63], v[192:195], v[112:127]
    ds_read_b128 v[68:71], v217 offset:16384
    ds_read_b64_tr_b16 v[160:161], v220 offset:9216
    ds_read_b64_tr_b16 v[162:163], v220 offset:9472
    v_mfma_f32_32x32x16_bf16 v[128:143], v[60:63], v[196:199], v[128:143]
    ds_read_b64_tr_b16 v[164:165], v221 offset:9216
    ds_read_b64_tr_b16 v[166:167], v221 offset:9472
    ds_read_b64_tr_b16 v[168:169], v222 offset:18432
    s_add_u32 m0, s61, 0
    s_nop 0
    buffer_load_dwordx4 v224, s[12:15], s78 offen lds
    s_add_u32 m0, s61, 1024
    v_mfma_f32_32x32x16_bf16 v[144:159], v[200:203], v[60:63], v[144:159]
    ds_read_b64_tr_b16 v[170:171], v222 offset:18944
    buffer_load_dwordx4 v225, s[12:15], s78 offen lds
    s_add_u32 m0, s62, 49152
    s_waitcnt lgkmcnt(7)
    v_mfma_f32_32x32x16_bf16 v[112:127], v[64:67], v[204:207], v[112:127]
    ds_read_b128 v[72:75], v218 offset:16384
    ds_read_b64_tr_b16 v[192:193], v220 offset:10240
    ds_read_b64_tr_b16 v[194:195], v220 offset:10496
    v_mfma_f32_32x32x16_bf16 v[128:143], v[64:67], v[208:211], v[128:143]
    ds_read_b64_tr_b16 v[196:197], v221 offset:10240
    ds_read_b64_tr_b16 v[198:199], v221 offset:10496
    ds_read_b64_tr_b16 v[200:201], v222 offset:20480
    buffer_load_dwordx4 v229, s[16:19], s85 offen lds
    s_add_u32 m0, s62, 57344
    v_mfma_f32_32x32x16_bf16 v[144:159], v[212:215], v[64:67], v[144:159]
    ds_read_b64_tr_b16 v[202:203], v222 offset:20992
    buffer_load_dwordx4 v230, s[20:23], s85 offen lds
    s_add_u32 m0, s62, 98304
    s_waitcnt lgkmcnt(7)
    v_mfma_f32_32x32x16_bf16 v[112:127], v[68:71], v[160:163], v[112:127]
    ds_read_b128 v[76:79], v219 offset:16384
    ds_read_b64_tr_b16 v[204:205], v220 offset:11264
    ds_read_b64_tr_b16 v[206:207], v220 offset:11520
    v_mfma_f32_32x32x16_bf16 v[128:143], v[68:71], v[164:167], v[128:143]
    ds_read_b64_tr_b16 v[208:209], v221 offset:11264
    ds_read_b64_tr_b16 v[210:211], v221 offset:11520
    ds_read_b64_tr_b16 v[212:213], v222 offset:22528
    buffer_load_dwordx4 v223, s[48:51], s92 offen lds
    v_mfma_f32_32x32x16_bf16 v[144:159], v[168:171], v[68:71], v[144:159]
    ds_read_b64_tr_b16 v[214:215], v222 offset:23040
    s_waitcnt lgkmcnt(7)
    v_mfma_f32_32x32x16_bf16 v[112:127], v[72:75], v[192:195], v[112:127]
    v_mfma_f32_32x32x16_bf16 v[128:143], v[72:75], v[196:199], v[128:143]
    s_waitcnt lgkmcnt(0)
    s_waitcnt vmcnt(5)
    s_barrier
    ds_read_b128 v[80:83], v216 offset:32768
    ds_read_b64_tr_b16 v[160:161], v220 offset:16384
    ds_read_b64_tr_b16 v[162:163], v220 offset:16640
    ds_read_b64_tr_b16 v[164:165], v221 offset:16384
    v_mfma_f32_32x32x16_bf16 v[144:159], v[200:203], v[72:75], v[144:159]
    ds_read_b64_tr_b16 v[166:167], v221 offset:16640
    ds_read_b64_tr_b16 v[168:169], v222 offset:32768
    ds_read_b64_tr_b16 v[170:171], v222 offset:33280
    s_mov_b32 s40, s64
    s_and_b32 s41, s65, 0xffff
    s_mov_b32 s42, 1605632
    s_mov_b32 s43, 0x20000
    s_and_b32 s10, s70, 3
    s_mul_i32 s10, s10, 448
    s_lshl_b32 s11, s24, 3
    s_add_u32 s10, s10, s11
    s_mul_i32 s10, s10, 896
    s_lshl_b32 s11, s71, 7
    s_add_u32 s10, s10, s11
    s_lshl_b32 s11, s34, 30
    s_add_u32 s60, s10, s11
    v_mul_u32_u24 v225, 896, v226
    v_cmp_gt_u32 vcc, 8, v226
    v_mov_b32 v237, 0x40000000
    s_nop 0
    v_cndmask_b32 v225, v237, v225, vcc
    s_add_u32 s29, s27, 48
    s_add_u32 s30, s28, 64
    v_and_b32 v253, 1, v226
    v_cmp_eq_u32 vcc, 0, v253
    v_mov_b32 v253, s30
    v_mov_b32 v254, s29
    v_cndmask_b32 v253, v253, v254, vcc
    v_lshlrev_b32 v253, 7, v253
    v_add_u32 v253, 86016, v253
    s_cmp_eq_u32 s24, 0
    s_cselect_b32 s29, 0, 0x40000000
    buffer_load_dword v254, v253, s[44:47], s29 offen sc1
    v_mfma_f32_32x32x16_bf16 v[112:127], v[76:79], v[204:207], v[112:127]
    ds_read_b128 v[84:87], v217 offset:32768
    ds_read_b64_tr_b16 v[192:193], v220 offset:17408
    ds_read_b64_tr_b16 v[194:195], v220 offset:17664
    v_mfma_f32_32x32x16_bf16 v[128:143], v[76:79], v[208:211], v[128:143]
    ds_read_b64_tr_b16 v[196:197], v221 offset:17408
    ds_read_b64_tr_b16 v[198:199], v221 offset:17664
    ds_read_b64_tr_b16 v[200:201], v222 offset:34816
    v_add_u32 v229, s39, v229
    v_add_u32 v230, s39, v230
    s_add_u32 m0, s62, 65536
    s_nop 0
    buffer_load_dwordx4 v229, s[16:19], s79 offen lds
    s_add_u32 m0, s62, 73728
    v_mfma_f32_32x32x16_bf16 v[144:159], v[212:215], v[76:79], v[144:159]
    ds_read_b64_tr_b16 v[202:203], v222 offset:35328
    buffer_load_dwordx4 v230, s[20:23], s79 offen lds
    s_waitcnt lgkmcnt(7)
    v_mfma_f32_32x32x16_bf16 v[112:127], v[80:83], v[160:163], v[112:127]
    ds_read_b128 v[88:91], v218 offset:32768
    ds_read_b64_tr_b16 v[204:205], v220 offset:18432
    ds_read_b64_tr_b16 v[206:207], v220 offset:18688
    v_mfma_f32_32x32x16_bf16 v[128:143], v[80:83], v[164:167], v[128:143]
    ds_read_b64_tr_b16 v[208:209], v221 offset:18432
    ds_read_b64_tr_b16 v[210:211], v221 offset:18688
    ds_read_b64_tr_b16 v[212:213], v222 offset:36864
    v_mfma_f32_32x32x16_bf16 v[144:159], v[168:171], v[80:83], v[144:159]
    ds_read_b64_tr_b16 v[214:215], v222 offset:37376
    s_waitcnt lgkmcnt(7)
    v_mfma_f32_32x32x16_bf16 v[112:127], v[84:87], v[192:195], v[112:127]
    ds_read_b128 v[92:95], v219 offset:32768
    ds_read_b64_tr_b16 v[160:161], v220 offset:19456
    ds_read_b64_tr_b16 v[162:163], v220 offset:19712
    v_mfma_f32_32x32x16_bf16 v[128:143], v[84:87], v[196:199], v[128:143]
    ds_read_b64_tr_b16 v[164:165], v221 offset:19456
    ds_read_b64_tr_b16 v[166:167], v221 offset:19712
    ds_read_b64_tr_b16 v[168:169], v222 offset:38912
    v_mfma_f32_32x32x16_bf16 v[144:159], v[200:203], v[84:87], v[144:159]
    ds_read_b64_tr_b16 v[170:171], v222 offset:39424
    s_waitcnt lgkmcnt(7)
    v_mfma_f32_32x32x16_bf16 v[112:127], v[88:91], v[204:207], v[112:127]
    v_mfma_f32_32x32x16_bf16 v[128:143], v[88:91], v[208:211], v[128:143]
    s_waitcnt vmcnt(2)
    s_cmp_lg_u32 s24, 0
    s_cbranch_scc1 L_prew_14
    v_cmp_gt_u32 vcc, 16, v254
    s_nop 4
    s_cbranch_vccnz L_prew_slow_15
L_prew_back_16:
L_prew_14:
    s_waitcnt lgkmcnt(0)
    s_barrier
    ds_read_b128 v[96:99], v216 offset:0
    ds_read_b64_tr_b16 v[192:193], v220 offset:0
    ds_read_b64_tr_b16 v[194:195], v220 offset:256
    ds_read_b64_tr_b16 v[196:197], v221 offset:0
    v_mfma_f32_32x32x16_bf16 v[144:159], v[212:215], v[88:91], v[144:159]
    ds_read_b64_tr_b16 v[198:199], v221 offset:256
    ds_read_b64_tr_b16 v[200:201], v222 offset:0
    ds_read_b64_tr_b16 v[202:203], v222 offset:512
    s_cmp_eq_u32 s34, 1
    s_cbranch_scc1 L_g1_scA_9
    s_mov_b32 s90, -1
    s_mov_b32 s91, 0
    s_lshl_b32 s29, s27, 7
    s_lshl_b32 s30, s26, 5
    s_add_u32 s29, s29, s30
    v_and_b32 v246, 31, v226
    v_add_u32 v246, s29, v246
    v_lshlrev_b32 v246, 3, v246
    v_add_u32 v246, 131072, v246
    buffer_load_dwordx2 v[234:235], v246, s[44:47], 0 offen sc1
    s_mul_i32 s29, s28, 1280
    s_add_u32 s29, s29, 66560
    v_and_b32 v247, 31, v226
    v_lshl_add_u32 v247, v247, 2, s29
    buffer_load_dword v231, v247, s[44:47], 0 offen sc1
    s_mul_i32 s29, s28, 1280
    s_add_u32 s29, s29, 66688
    v_and_b32 v247, 31, v226
    v_lshl_add_u32 v247, v247, 2, s29
    buffer_load_dword v232, v247, s[44:47], 0 offen sc1
    s_mul_i32 s29, s28, 1280
    s_mov_b32 s31, 0
    s_lshl_b32 s31, s31, 6
    s_add_u32 s29, s29, s31
    s_add_u32 s29, s29, 65536
    v_and_b32 v247, 15, v226
    v_lshl_add_u32 v247, v247, 2, s29
    v_bfe_u32 v253, v226, 4, 1
    v_lshl_add_u32 v247, v253, 9, v247
    buffer_load_dword v233, v247, s[44:47], 0 offen sc1
    s_branch L_g1_scD_10
L_g1_scA_9:
    s_mov_b32 s90, -1
    s_mov_b32 s91, 0
    s_lshl_b32 s29, s27, 7
    s_lshl_b32 s30, s26, 5
    s_add_u32 s29, s29, s30
    v_and_b32 v246, 31, v226
    v_add_u32 v246, s29, v246
    v_lshlrev_b32 v246, 3, v246
    v_add_u32 v246, 131072, v246
    buffer_load_dwordx2 v[234:235], v246, s[44:47], 0 offen sc1
    s_mul_i32 s29, s28, 1280
    s_add_u32 s29, s29, 66560
    v_and_b32 v247, 31, v226
    v_lshl_add_u32 v247, v247, 2, s29
    buffer_load_dword v231, v247, s[44:47], 0 offen sc1
    s_mul_i32 s29, s28, 1280
    s_add_u32 s29, s29, 66688
    v_and_b32 v247, 31, v226
    v_lshl_add_u32 v247, v247, 2, s29
    buffer_load_dword v232, v247, s[44:47], 0 offen sc1
    s_mul_i32 s29, s28, 1280
    s_mov_b32 s31, 0
    s_mul_i32 s31, s31, 112
    s_add_u32 s29, s29, s31
    s_add_u32 s29, s29, 65536
    v_and_b32 v247, 31, v226
    v_lshl_add_u32 v247, v247, 2, s29
    buffer_load_dword v233, v247, s[44:47], 0 offen sc1
L_g1_scD_10:
    v_mfma_f32_32x32x16_bf16 v[112:127], v[92:95], v[160:163], v[112:127]
    ds_read_b128 v[100:103], v217 offset:0
    ds_read_b64_tr_b16 v[204:205], v220 offset:1024
    ds_read_b64_tr_b16 v[206:207], v220 offset:1280
    v_mfma_f32_32x32x16_bf16 v[128:143], v[92:95], v[164:167], v[128:143]
    ds_read_b64_tr_b16 v[208:209], v221 offset:1024
    ds_read_b64_tr_b16 v[210:211], v221 offset:1280
    ds_read_b64_tr_b16 v[212:213], v222 offset:2048
    s_add_u32 m0, s62, 81920
    s_nop 0
    buffer_load_dwordx4 v229, s[16:19], s80 offen lds
    s_add_u32 m0, s62, 90112
    v_mfma_f32_32x32x16_bf16 v[144:159], v[168:171], v[92:95], v[144:159]
    ds_read_b64_tr_b16 v[214:215], v222 offset:2560
    buffer_load_dwordx4 v230, s[20:23], s80 offen lds
    s_waitcnt lgkmcnt(7)
    v_mfma_f32_32x32x16_bf16 v[112:127], v[96:99], v[192:195], v[112:127]
    ds_read_b128 v[104:107], v218 offset:0
    ds_read_b64_tr_b16 v[160:161], v220 offset:2048
    ds_read_b64_tr_b16 v[162:163], v220 offset:2304
    v_mfma_f32_32x32x16_bf16 v[128:143], v[96:99], v[196:199], v[128:143]
    ds_read_b64_tr_b16 v[164:165], v221 offset:2048
    ds_read_b64_tr_b16 v[166:167], v221 offset:2304
    ds_read_b64_tr_b16 v[168:169], v222 offset:4096
    buffer_load_dword v237, v225, s[40:43], s60 offen
    s_add_u32 s60, s60, 57344
    v_mfma_f32_32x32x16_bf16 v[144:159], v[200:203], v[96:99], v[144:159]
    ds_read_b64_tr_b16 v[170:171], v222 offset:4608
    s_waitcnt lgkmcnt(7)
    v_mfma_f32_32x32x16_bf16 v[112:127], v[100:103], v[204:207], v[112:127]
    ds_read_b128 v[108:111], v219 offset:0
    ds_read_b64_tr_b16 v[192:193], v220 offset:3072
    ds_read_b64_tr_b16 v[194:195], v220 offset:3328
    v_mfma_f32_32x32x16_bf16 v[128:143], v[100:103], v[208:211], v[128:143]
    ds_read_b64_tr_b16 v[196:197], v221 offset:3072
    ds_read_b64_tr_b16 v[198:199], v221 offset:3328
    ds_read_b64_tr_b16 v[200:201], v222 offset:6144
    v_mfma_f32_32x32x16_bf16 v[144:159], v[212:215], v[100:103], v[144:159]
    ds_read_b64_tr_b16 v[202:203], v222 offset:6656
    s_waitcnt lgkmcnt(7)
    v_mfma_f32_32x32x16_bf16 v[112:127], v[104:107], v[160:163], v[112:127]
    v_mfma_f32_32x32x16_bf16 v[128:143], v[104:107], v[164:167], v[128:143]
    v_mfma_f32_32x32x16_bf16 v[144:159], v[168:171], v[104:107], v[144:159]
    s_waitcnt lgkmcnt(0)
    v_mfma_f32_32x32x16_bf16 v[112:127], v[108:111], v[192:195], v[112:127]
    v_mfma_f32_32x32x16_bf16 v[128:143], v[108:111], v[196:199], v[128:143]
    v_mfma_f32_32x32x16_bf16 v[144:159], v[200:203], v[108:111], v[144:159]
    s_waitcnt lgkmcnt(0)
    s_waitcnt vmcnt(7)
    s_barrier
    s_add_u32 m0, s62, 49152
    s_nop 0
    buffer_load_dwordx4 v229, s[16:19], s81 offen lds
    s_add_u32 m0, s62, 57344
    s_nop 0
    buffer_load_dwordx4 v230, s[20:23], s81 offen lds
    buffer_load_dword v237, v225, s[40:43], s60 offen
    s_add_u32 s60, s60, 57344
    s_cmp_eq_u32 s34, 1
    s_cbranch_scc1 L_g1_A_17
    ds_read_b64_tr_b16 v[192:193], v227 offset:16384
    ds_read_b64_tr_b16 v[194:195], v227 offset:16896
    ds_read_b64_tr_b16 v[196:197], v228 offset:16384
    ds_read_b64_tr_b16 v[198:199], v228 offset:16896
    ds_read_b64_tr_b16 v[200:201], v227 offset:18432
    ds_read_b64_tr_b16 v[202:203], v227 offset:18944
    ds_read_b64_tr_b16 v[204:205], v228 offset:18432
    ds_read_b64_tr_b16 v[206:207], v228 offset:18944
    s_waitcnt lgkmcnt(4)
    v_mfma_f32_32x32x16_bf16 v[160:175], v[192:195], v[0:3], 0
    s_waitcnt vmcnt(6)
    v_xor_b32 v246, 0x8000, v235
    v_mul_f32 v236, v234, v234
    v_rcp_f32 v234, v234
    v_lshl_or_b32 v238, v246, 16, v246
    v_mov_b32 v239, v246
    v_mov_b32 v240, 0
    v_mov_b32 v241, 0
    v_mfma_f32_32x32x16_bf16 v[176:191], v[196:199], v[0:3], 0
    v_mov_b32 v244, 0
    v_mov_b32 v245, 0
    s_mov_b32 s29, 3216550459
    v_mul_f32 v235, s29, v234
    v_mov_b32 v254, 3049366176
    v_mov_b32 v255, s33
    s_lshl_b32 s30, s28, 3
    s_lshl_b32 s29, s27, 2
    s_add_u32 s29, s29, s26
    s_mul_i32 s29, s29, 144
    s_add_u32 s29, s29, s30
    s_lshl_b32 s29, s29, 10
    s_add_u32 s29, s29, 1048576
    v_lshlrev_b32 v224, 4, v226
    v_add_u32 v224, s29, v224
    s_lshl_b32 s29, s26, 7
    s_add_u32 s29, s29, 149504
    v_and_b32 v252, 31, v226
    s_waitcnt lgkmcnt(0)
    v_mfma_f32_32x32x16_bf16 v[160:175], v[200:203], v[4:7], v[160:175]
    ds_read_b64_tr_b16 v[192:193], v227 offset:22528
    ds_read_b64_tr_b16 v[194:195], v227 offset:23040
    v_lshl_add_u32 v252, v252, 2, s29
    ds_write_b32 v252, v234
    v_lshrrev_b32 v253, 5, v226
    v_lshl_add_u32 v253, v253, 4, s29
    v_cndmask_b32 v231, 0, v231, s[90:91]
    v_and_b32 v246, s3, v231
    v_sub_f32 v231, v231, v246
    v_and_b32 v247, s3, v231
    v_mfma_f32_32x32x16_bf16 v[176:191], v[204:207], v[4:7], v[176:191]
    ds_read_b64_tr_b16 v[196:197], v228 offset:22528
    ds_read_b64_tr_b16 v[198:199], v228 offset:23040
    v_lshrrev_b32 v246, 16, v246
    v_sub_f32 v231, v231, v247
    v_or_b32 v242, v246, v247
    v_lshrrev_b32 v243, 16, v231
    s_nop 1
    v_mfma_f32_32x32x16_bf16 v[112:127], v[238:241], v[242:245], v[112:127]
    s_waitcnt lgkmcnt(2)
    ds_read_b128 v[208:211], v253 offset:0
    ds_read_b128 v[212:215], v253 offset:32
    ds_read_b64_tr_b16 v[0:1], v227 offset:20480
    ds_read_b64_tr_b16 v[2:3], v227 offset:20992
    ds_read_b64_tr_b16 v[4:5], v228 offset:20480
    ds_read_b64_tr_b16 v[6:7], v228 offset:20992
    s_waitcnt lgkmcnt(0)
    v_mfma_f32_32x32x16_bf16 v[160:175], v[0:3], v[8:11], v[160:175]
    s_waitcnt lgkmcnt(0)
    s_waitcnt vmcnt(4)
    s_barrier
    ds_read_b64_tr_b16 v[200:201], v227 offset:32768
    ds_read_b64_tr_b16 v[202:203], v227 offset:33280
    v_cndmask_b32 v232, 0, v232, s[90:91]
    v_and_b32 v246, s3, v232
    v_sub_f32 v232, v232, v246
    v_and_b32 v247, s3, v232
    v_lshrrev_b32 v246, 16, v246
    v_sub_f32 v232, v232, v247
    v_or_b32 v242, v246, v247
    v_lshrrev_b32 v243, 16, v232
    s_nop 1
    v_mfma_f32_32x32x16_bf16 v[176:191], v[4:7], v[8:11], v[176:191]
    ds_read_b64_tr_b16 v[204:205], v228 offset:32768
    ds_read_b64_tr_b16 v[206:207], v228 offset:33280
    v_mfma_f32_32x32x16_bf16 v[128:143], v[238:241], v[242:245], v[128:143]
    v_cndmask_b32 v233, 0, v233, s[90:91]
    v_and_b32 v246, s3, v233
    v_sub_f32 v233, v233, v246
    v_and_b32 v247, s3, v233
    v_lshrrev_b32 v246, 16, v246
    v_sub_f32 v233, v233, v247
    v_mfma_f32_32x32x16_bf16 v[160:175], v[192:195], v[12:15], v[160:175]
    ds_read_b64_tr_b16 v[0:1], v227 offset:34816
    ds_read_b64_tr_b16 v[2:3], v227 offset:35328
    v_or_b32 v242, v246, v247
    v_lshrrev_b32 v243, 16, v233
    s_nop 1
    v_mfma_f32_32x32x16_bf16 v[144:159], v[242:245], v[238:241], v[144:159]
    v_mul_f32 v128, v128, v208
    v_mul_f32 v129, v129, v209
    v_mul_f32 v130, v130, v210
    v_mul_f32 v131, v131, v211
    v_mfma_f32_32x32x16_bf16 v[176:191], v[196:199], v[12:15], v[176:191]
    ds_read_b64_tr_b16 v[4:5], v228 offset:34816
    ds_read_b64_tr_b16 v[6:7], v228 offset:35328
    v_mul_f32 v132, v132, v212
    v_mul_f32 v133, v133, v213
    v_mul_f32 v134, v134, v214
    v_mul_f32 v135, v135, v215
    v_fma_f32 v112, v112, v208, v255
    v_fma_f32 v113, v113, v209, v255
    v_fma_f32 v114, v114, v210, v255
    v_fma_f32 v115, v115, v211, v255
    s_add_u32 m0, s62, 65536
    s_nop 0
    buffer_load_dwordx4 v229, s[16:19], s82 offen lds
    s_add_u32 m0, s62, 73728
    s_nop 0
    buffer_load_dwordx4 v230, s[20:23], s82 offen lds
    s_waitcnt lgkmcnt(4)
    v_mfma_f32_32x32x16_bf16 v[160:175], v[200:203], v[16:19], v[160:175]
    ds_read_b64_tr_b16 v[192:193], v227 offset:36864
    ds_read_b64_tr_b16 v[194:195], v227 offset:37376
    v_fma_f32 v116, v116, v212, v255
    v_fma_f32 v117, v117, v213, v255
    v_fma_f32 v118, v118, v214, v255
    v_fma_f32 v119, v119, v215, v255
    v_fma_f32 v216, v112, s93, v254
    v_fma_f32 v217, v113, s93, v254
    v_fma_f32 v218, v114, s93, v254
    v_fma_f32 v219, v115, s93, v254
    v_mfma_f32_32x32x16_bf16 v[176:191], v[204:207], v[16:19], v[176:191]
    ds_read_b64_tr_b16 v[196:197], v228 offset:36864
    ds_read_b64_tr_b16 v[198:199], v228 offset:37376
    v_fma_f32 v220, v116, s93, v254
    v_fma_f32 v221, v117, s93, v254
    v_fma_f32 v222, v118, s93, v254
    v_fma_f32 v223, v119, s93, v254
    v_exp_f32_e64 v216, v216 clamp
    v_exp_f32_e64 v217, v217 clamp
    buffer_load_dword v237, v225, s[40:43], s60 offen
    s_add_u32 s60, s60, 57344
    buffer_load_dword v237, v225, s[40:43], s60 offen
    s_add_u32 s60, s60, 57344
    s_waitcnt lgkmcnt(4)
    v_mfma_f32_32x32x16_bf16 v[160:175], v[0:3], v[20:23], v[160:175]
    ds_read_b64_tr_b16 v[200:201], v227 offset:38912
    ds_read_b64_tr_b16 v[202:203], v227 offset:39424
    v_exp_f32_e64 v218, v218 clamp
    v_exp_f32_e64 v219, v219 clamp
    v_exp_f32_e64 v220, v220 clamp
    v_exp_f32_e64 v221, v221 clamp
    v_mfma_f32_32x32x16_bf16 v[176:191], v[4:7], v[20:23], v[176:191]
    ds_read_b64_tr_b16 v[204:205], v228 offset:38912
    ds_read_b64_tr_b16 v[206:207], v228 offset:39424
    v_exp_f32_e64 v222, v222 clamp
    v_exp_f32_e64 v223, v223 clamp
    v_max_f32 v112, s33, v112
    v_max_f32 v113, s33, v113
    v_max_f32 v114, s33, v114
    v_max_f32 v115, s33, v115
    s_waitcnt lgkmcnt(4)
    v_mfma_f32_32x32x16_bf16 v[160:175], v[192:195], v[24:27], v[160:175]
    s_waitcnt lgkmcnt(0)
    s_waitcnt vmcnt(5)
    s_barrier
    ds_read_b64_tr_b16 v[0:1], v227 offset:0
    ds_read_b64_tr_b16 v[2:3], v227 offset:512
    v_max_f32 v116, s33, v116
    v_max_f32 v117, s33, v117
    v_max_f32 v118, s33, v118
    v_max_f32 v119, s33, v119
    v_add_f32 v112, v112, v216
    v_add_f32 v113, v113, v217
    v_add_f32 v114, v114, v218
    v_add_f32 v115, v115, v219
    v_mfma_f32_32x32x16_bf16 v[176:191], v[196:199], v[24:27], v[176:191]
    ds_read_b64_tr_b16 v[4:5], v228 offset:0
    ds_read_b64_tr_b16 v[6:7], v228 offset:512
    v_add_f32 v116, v116, v220
    v_add_f32 v117, v117, v221
    v_add_f32 v118, v118, v222
    v_add_f32 v119, v119, v223
    v_cvt_pk_bf16_f32 v112, v112, v113
    v_cvt_pk_bf16_f32 v113, v114, v115
    v_cvt_pk_bf16_f32 v114, v116, v117
    v_cvt_pk_bf16_f32 v115, v118, v119
    v_mfma_f32_32x32x16_bf16 v[160:175], v[200:203], v[28:31], v[160:175]
    ds_read_b64_tr_b16 v[192:193], v227 offset:2048
    ds_read_b64_tr_b16 v[194:195], v227 offset:2560
    v_cvt_pk_bf16_f32 v128, v128, v129
    v_cvt_pk_bf16_f32 v129, v130, v131
    v_cvt_pk_bf16_f32 v130, v132, v133
    v_cvt_pk_bf16_f32 v131, v134, v135
    ds_read_b128 v[208:211], v253 offset:64
    ds_read_b128 v[212:215], v253 offset:96
    v_and_b32 v246, 31, v226
    s_lshr_b32 s29, s35, 1
    v_subrev_u32 v247, s29, v246
    s_cmp_eq_u32 s35, 0
    s_cselect_b32 s30, 28, 0
    v_mfma_f32_32x32x16_bf16 v[176:191], v[204:207], v[28:31], v[176:191]
    ds_read_b64_tr_b16 v[196:197], v228 offset:2048
    ds_read_b64_tr_b16 v[198:199], v228 offset:2560
    v_cmp_eq_u32 s[30:31], s30, v246
    v_mov_b32 v248, 0
    v_mov_b32 v249, s63
    v_cndmask_b32 v248, v248, v249, s[30:31]
    v_mov_b32 v249, 0
    s_waitcnt lgkmcnt(2)
    v_mul_f32 v136, v136, v208
    v_mul_f32 v137, v137, v209
    v_mul_f32 v138, v138, v210
    s_add_u32 m0, s62, 81920
    s_nop 0
    buffer_load_dwordx4 v229, s[16:19], s83 offen lds
    s_add_u32 m0, s62, 90112
    s_nop 0
    buffer_load_dwordx4 v230, s[20:23], s83 offen lds
    v_mfma_f32_32x32x16_bf16 v[160:175], v[0:3], v[32:35], v[160:175]
    ds_read_b64_tr_b16 v[200:201], v227 offset:4096
    ds_read_b64_tr_b16 v[202:203], v227 offset:4608
    v_mul_f32 v139, v139, v211
    v_mul_f32 v140, v140, v212
    v_mul_f32 v141, v141, v213
    v_mul_f32 v142, v142, v214
    v_mul_f32 v143, v143, v215
    v_fma_f32 v120, v120, v208, v255
    v_fma_f32 v121, v121, v209, v255
    v_fma_f32 v122, v122, v210, v255
    v_mfma_f32_32x32x16_bf16 v[176:191], v[4:7], v[32:35], v[176:191]
    ds_read_b64_tr_b16 v[204:205], v228 offset:4096
    ds_read_b64_tr_b16 v[206:207], v228 offset:4608
    v_fma_f32 v123, v123, v211, v255
    v_fma_f32 v124, v124, v212, v255
    v_fma_f32 v125, v125, v213, v255
    v_fma_f32 v126, v126, v214, v255
    v_fma_f32 v127, v127, v215, v255
    v_fma_f32 v216, v120, s93, v254
    v_fma_f32 v217, v121, s93, v254
    v_fma_f32 v218, v122, s93, v254
    buffer_load_dword v237, v225, s[40:43], s60 offen
    s_add_u32 s60, s60, 57344
    buffer_load_dword v237, v225, s[40:43], s60 offen
    s_add_u32 s60, s60, 57344
    s_waitcnt lgkmcnt(4)
    v_mfma_f32_32x32x16_bf16 v[160:175], v[192:195], v[36:39], v[160:175]
    ds_read_b64_tr_b16 v[0:1], v227 offset:6144
    ds_read_b64_tr_b16 v[2:3], v227 offset:6656
    v_fma_f32 v219, v123, s93, v254
    v_fma_f32 v220, v124, s93, v254
    v_fma_f32 v221, v125, s93, v254
    v_fma_f32 v222, v126, s93, v254
    v_fma_f32 v223, v127, s93, v254
    v_exp_f32_e64 v216, v216 clamp
    v_exp_f32_e64 v217, v217 clamp
    v_mfma_f32_32x32x16_bf16 v[176:191], v[196:199], v[36:39], v[176:191]
    ds_read_b64_tr_b16 v[4:5], v228 offset:6144
    ds_read_b64_tr_b16 v[6:7], v228 offset:6656
    v_exp_f32_e64 v218, v218 clamp
    v_exp_f32_e64 v219, v219 clamp
    v_exp_f32_e64 v220, v220 clamp
    v_exp_f32_e64 v221, v221 clamp
    s_waitcnt lgkmcnt(4)
    v_mfma_f32_32x32x16_bf16 v[160:175], v[200:203], v[40:43], v[160:175]
    s_waitcnt lgkmcnt(0)
    s_waitcnt vmcnt(6)
    s_barrier
    ds_read_b64_tr_b16 v[192:193], v227 offset:16384
    ds_read_b64_tr_b16 v[194:195], v227 offset:16896
    v_exp_f32_e64 v222, v222 clamp
    v_exp_f32_e64 v223, v223 clamp
    v_max_f32 v120, s33, v120
    v_max_f32 v121, s33, v121
    v_max_f32 v122, s33, v122
    v_max_f32 v123, s33, v123
    v_mfma_f32_32x32x16_bf16 v[176:191], v[204:207], v[40:43], v[176:191]
    ds_read_b64_tr_b16 v[196:197], v228 offset:16384
    ds_read_b64_tr_b16 v[198:199], v228 offset:16896
    v_max_f32 v124, s33, v124
    v_max_f32 v125, s33, v125
    v_max_f32 v126, s33, v126
    v_max_f32 v127, s33, v127
    v_add_f32 v120, v120, v216
    v_add_f32 v121, v121, v217
    v_add_f32 v122, v122, v218
    v_add_f32 v123, v123, v219
    v_mfma_f32_32x32x16_bf16 v[160:175], v[0:3], v[44:47], v[160:175]
    ds_read_b64_tr_b16 v[200:201], v227 offset:18432
    ds_read_b64_tr_b16 v[202:203], v227 offset:18944
    v_add_f32 v124, v124, v220
    v_add_f32 v125, v125, v221
    v_add_f32 v126, v126, v222
    v_add_f32 v127, v127, v223
    v_cvt_pk_bf16_f32 v116, v120, v121
    v_cvt_pk_bf16_f32 v117, v122, v123
    v_cvt_pk_bf16_f32 v118, v124, v125
    v_cvt_pk_bf16_f32 v119, v126, v127
    v_mfma_f32_32x32x16_bf16 v[176:191], v[4:7], v[44:47], v[176:191]
    ds_read_b64_tr_b16 v[204:205], v228 offset:18432
    ds_read_b64_tr_b16 v[206:207], v228 offset:18944
    v_cvt_pk_bf16_f32 v132, v136, v137
    v_cvt_pk_bf16_f32 v133, v138, v139
    v_cvt_pk_bf16_f32 v134, v140, v141
    v_cvt_pk_bf16_f32 v135, v142, v143
    v_cmp_gt_u32 vcc, 28, v247
    s_nop 1
    v_cndmask_b32 v112, v249, v112, vcc
    v_cndmask_b32 v128, v248, v128, vcc
    v_cndmask_b32 v113, v249, v113, vcc
    s_add_u32 m0, s62, 49152
    s_nop 0
    buffer_load_dwordx4 v229, s[16:19], s84 offen lds
    s_add_u32 m0, s62, 57344
    s_nop 0
    buffer_load_dwordx4 v230, s[20:23], s84 offen lds
    s_waitcnt lgkmcnt(4)
    v_mfma_f32_32x32x16_bf16 v[160:175], v[192:195], v[48:51], v[160:175]
    ds_read_b64_tr_b16 v[0:1], v227 offset:20480
    ds_read_b64_tr_b16 v[2:3], v227 offset:20992
    v_cndmask_b32 v129, v248, v129, vcc
    v_cndmask_b32 v114, v249, v114, vcc
    v_cndmask_b32 v130, v248, v130, vcc
    v_cndmask_b32 v115, v249, v115, vcc
    v_cndmask_b32 v131, v248, v131, vcc
    v_cndmask_b32 v116, v249, v116, vcc
    v_cndmask_b32 v132, v248, v132, vcc
    v_cndmask_b32 v117, v249, v117, vcc
    v_mfma_f32_32x32x16_bf16 v[176:191], v[196:199], v[48:51], v[176:191]
    ds_read_b64_tr_b16 v[4:5], v228 offset:20480
    ds_read_b64_tr_b16 v[6:7], v228 offset:20992
    v_cndmask_b32 v133, v248, v133, vcc
    v_cndmask_b32 v118, v249, v118, vcc
    v_cndmask_b32 v134, v248, v134, vcc
    v_cndmask_b32 v119, v249, v119, vcc
    v_cndmask_b32 v135, v248, v135, vcc
    s_nop 1
    v_mfma_f32_32x32x16_bf16 v[208:223], v[112:115], v[128:131], 0
    v_mfma_f32_32x32x16_bf16 v[208:223], v[116:119], v[132:135], v[208:223]
    s_lshl_b32 s29, s26, 12
    s_add_u32 s29, s29, 133120
    buffer_load_dword v237, v225, s[40:43], s60 offen
    s_add_u32 s60, s60, 57344
    s_waitcnt lgkmcnt(4)
    v_mfma_f32_32x32x16_bf16 v[160:175], v[200:203], v[52:55], v[160:175]
    ds_read_b64_tr_b16 v[192:193], v227 offset:22528
    ds_read_b64_tr_b16 v[194:195], v227 offset:23040
    v_lshlrev_b32 v246, 4, v226
    v_add_u32 v246, s29, v246
    s_nop 13
    ds_write_b128 v246, v[208:211] offset:0
    ds_write_b128 v246, v[212:215] offset:1024
    ds_write_b128 v246, v[216:219] offset:2048
    ds_write_b128 v246, v[220:223] offset:3072
    v_mfma_f32_32x32x16_bf16 v[176:191], v[204:207], v[52:55], v[176:191]
    ds_read_b64_tr_b16 v[196:197], v228 offset:22528
    ds_read_b64_tr_b16 v[198:199], v228 offset:23040
    s_waitcnt lgkmcnt(8)
    v_mfma_f32_32x32x16_bf16 v[160:175], v[0:3], v[56:59], v[160:175]
    s_waitcnt lgkmcnt(0)
    s_waitcnt vmcnt(5)
    s_barrier
    ds_read_b64_tr_b16 v[200:201], v227 offset:32768
    ds_read_b64_tr_b16 v[202:203], v227 offset:33280
    s_lshl_b32 s29, s26, 10
    s_add_u32 s29, s29, 133120
    v_lshlrev_b32 v246, 4, v226
    v_add_u32 v246, s29, v246
    ds_read_b128 v[128:131], v246 offset:0
    ds_read_b128 v[132:135], v246 offset:4096
    v_mfma_f32_32x32x16_bf16 v[176:191], v[4:7], v[56:59], v[176:191]
    ds_read_b64_tr_b16 v[204:205], v228 offset:32768
    ds_read_b64_tr_b16 v[206:207], v228 offset:33280
    ds_read_b128 v[136:139], v246 offset:8192
    ds_read_b128 v[140:143], v246 offset:12288
    s_lshl_b32 s29, s28, 12
    s_lshl_b32 s30, s26, 10
    s_add_u32 s29, s29, s30
    s_add_u32 s29, s29, 0
    v_lshlrev_b32 v251, 2, v226
    v_add_u32 v251, s29, v251
    v_mfma_f32_32x32x16_bf16 v[160:175], v[192:195], v[60:63], v[160:175]
    ds_read_b64_tr_b16 v[0:1], v227 offset:34816
    ds_read_b64_tr_b16 v[2:3], v227 offset:35328
    v_mul_f32 v208, v144, v235
    v_mul_f32 v209, v145, v235
    v_mul_f32 v210, v146, v235
    v_mul_f32 v211, v147, v235
    v_mfma_f32_32x32x16_bf16 v[176:191], v[196:199], v[60:63], v[176:191]
    ds_read_b64_tr_b16 v[4:5], v228 offset:34816
    ds_read_b64_tr_b16 v[6:7], v228 offset:35328
    v_exp_f32 v208, v208
    v_exp_f32 v209, v209
    s_add_u32 m0, s62, 65536
    s_nop 0
    buffer_load_dwordx4 v229, s[16:19], s85 offen lds
    s_add_u32 m0, s62, 73728
    s_nop 0
    buffer_load_dwordx4 v230, s[20:23], s85 offen lds
    s_waitcnt lgkmcnt(6)
    v_mfma_f32_32x32x16_bf16 v[160:175], v[200:203], v[64:67], v[160:175]
    ds_read_b64_tr_b16 v[192:193], v227 offset:36864
    ds_read_b64_tr_b16 v[194:195], v227 offset:37376
    v_exp_f32 v210, v210
    v_exp_f32 v211, v211
    v_mfma_f32_32x32x16_bf16 v[176:191], v[204:207], v[64:67], v[176:191]
    ds_read_b64_tr_b16 v[196:197], v228 offset:36864
    ds_read_b64_tr_b16 v[198:199], v228 offset:37376
    v_mul_f32 v144, v144, v152
    v_mul_f32 v145, v145, v153
    v_mul_f32 v146, v146, v154
    v_mul_f32 v147, v147, v155
    s_mov_b32 s40, s68
    s_and_b32 s41, s69, 0xffff
    s_mov_b32 s42, 401408
    s_and_b32 s10, s70, 3
    s_mul_i32 s10, s10, 112
    s_lshl_b32 s11, s24, 3
    s_add_u32 s10, s10, s11
    s_mul_i32 s10, s10, 896
    s_lshl_b32 s11, s71, 7
    s_add_u32 s10, s10, s11
    s_lshl_b32 s11, s34, 30
    s_add_u32 s60, s10, s11
    buffer_load_dword v237, v225, s[40:43], s60 offen
    s_add_u32 s60, s60, 57344
    s_waitcnt lgkmcnt(4)
    v_mfma_f32_32x32x16_bf16 v[160:175], v[0:3], v[68:71], v[160:175]
    ds_read_b64_tr_b16 v[200:201], v227 offset:38912
    ds_read_b64_tr_b16 v[202:203], v227 offset:39424
    v_fma_f32 v208, v208, v236, v236
    v_fma_f32 v209, v209, v236, v236
    v_fma_f32 v210, v210, v236, v236
    v_fma_f32 v211, v211, v236, v236
    v_mfma_f32_32x32x16_bf16 v[176:191], v[4:7], v[68:71], v[176:191]
    ds_read_b64_tr_b16 v[204:205], v228 offset:38912
    ds_read_b64_tr_b16 v[206:207], v228 offset:39424
    v_rcp_f32 v208, v208
    v_rcp_f32 v209, v209
    s_waitcnt lgkmcnt(4)
    v_mfma_f32_32x32x16_bf16 v[160:175], v[192:195], v[72:75], v[160:175]
    s_waitcnt lgkmcnt(0)
    s_waitcnt vmcnt(4)
    s_barrier
    ds_read_b64_tr_b16 v[0:1], v227 offset:0
    ds_read_b64_tr_b16 v[2:3], v227 offset:512
    v_rcp_f32 v210, v210
    v_rcp_f32 v211, v211
    v_mfma_f32_32x32x16_bf16 v[176:191], v[196:199], v[72:75], v[176:191]
    ds_read_b64_tr_b16 v[4:5], v228 offset:0
    ds_read_b64_tr_b16 v[6:7], v228 offset:512
    v_mul_f32 v144, v144, v208
    v_mul_f32 v145, v145, v209
    v_mul_f32 v146, v146, v210
    v_mul_f32 v147, v147, v211
    v_mfma_f32_32x32x16_bf16 v[160:175], v[200:203], v[76:79], v[160:175]
    ds_read_b64_tr_b16 v[192:193], v227 offset:2048
    ds_read_b64_tr_b16 v[194:195], v227 offset:2560
    v_add_f32 v128, v128, v132
    v_add_f32 v136, v136, v140
    v_add_f32 v129, v129, v133
    v_add_f32 v137, v137, v141
    v_mfma_f32_32x32x16_bf16 v[176:191], v[204:207], v[76:79], v[176:191]
    ds_read_b64_tr_b16 v[196:197], v228 offset:2048
    ds_read_b64_tr_b16 v[198:199], v228 offset:2560
    v_add_f32 v130, v130, v134
    v_add_f32 v138, v138, v142
    v_add_f32 v131, v131, v135
    v_add_f32 v139, v139, v143
    buffer_load_dword v237, v225, s[40:43], s60 offen
    s_add_u32 s60, s60, 57344
    s_waitcnt lgkmcnt(4)
    v_mfma_f32_32x32x16_bf16 v[160:175], v[0:3], v[80:83], v[160:175]
    ds_read_b64_tr_b16 v[200:201], v227 offset:4096
    ds_read_b64_tr_b16 v[202:203], v227 offset:4608
    v_add_f32 v120, v128, v136
    v_add_f32 v121, v129, v137
    v_add_f32 v122, v130, v138
    v_add_f32 v123, v131, v139
    v_mfma_f32_32x32x16_bf16 v[176:191], v[4:7], v[80:83], v[176:191]
    ds_read_b64_tr_b16 v[204:205], v228 offset:4096
    ds_read_b64_tr_b16 v[206:207], v228 offset:4608
    buffer_atomic_add_f32 v120, v251, s[44:47], 0 offen offset:0
    buffer_atomic_add_f32 v121, v251, s[44:47], 0 offen offset:256
    buffer_atomic_add_f32 v122, v251, s[44:47], 0 offen offset:512
    buffer_atomic_add_f32 v123, v251, s[44:47], 0 offen offset:768
    s_waitcnt lgkmcnt(4)
    v_mfma_f32_32x32x16_bf16 v[160:175], v[192:195], v[84:87], v[160:175]
    ds_read_b64_tr_b16 v[0:1], v227 offset:6144
    ds_read_b64_tr_b16 v[2:3], v227 offset:6656
    v_mul_f32 v208, v148, v235
    v_mul_f32 v209, v149, v235
    v_mul_f32 v210, v150, v235
    v_mul_f32 v211, v151, v235
    v_mfma_f32_32x32x16_bf16 v[176:191], v[196:199], v[84:87], v[176:191]
    ds_read_b64_tr_b16 v[4:5], v228 offset:6144
    ds_read_b64_tr_b16 v[6:7], v228 offset:6656
    v_exp_f32 v208, v208
    v_exp_f32 v209, v209
    s_waitcnt lgkmcnt(4)
    v_mfma_f32_32x32x16_bf16 v[160:175], v[200:203], v[88:91], v[160:175]
    s_waitcnt lgkmcnt(0)
    s_waitcnt vmcnt(6)
    s_barrier
    ds_read_b64_tr_b16 v[192:193], v227 offset:16384
    ds_read_b64_tr_b16 v[194:195], v227 offset:16896
    v_exp_f32 v210, v210
    v_exp_f32 v211, v211
    v_mfma_f32_32x32x16_bf16 v[176:191], v[204:207], v[88:91], v[176:191]
    ds_read_b64_tr_b16 v[196:197], v228 offset:16384
    ds_read_b64_tr_b16 v[198:199], v228 offset:16896
    v_mul_f32 v148, v148, v156
    v_mul_f32 v149, v149, v157
    v_mul_f32 v150, v150, v158
    v_mul_f32 v151, v151, v159
    v_mfma_f32_32x32x16_bf16 v[160:175], v[0:3], v[92:95], v[160:175]
    ds_read_b64_tr_b16 v[200:201], v227 offset:18432
    ds_read_b64_tr_b16 v[202:203], v227 offset:18944
    v_fma_f32 v208, v208, v236, v236
    v_fma_f32 v209, v209, v236, v236
    v_fma_f32 v210, v210, v236, v236
    v_fma_f32 v211, v211, v236, v236
    v_mfma_f32_32x32x16_bf16 v[176:191], v[4:7], v[92:95], v[176:191]
    ds_read_b64_tr_b16 v[204:205], v228 offset:18432
    ds_read_b64_tr_b16 v[206:207], v228 offset:18944
    v_rcp_f32 v208, v208
    v_rcp_f32 v209, v209
    s_waitcnt lgkmcnt(4)
    v_mfma_f32_32x32x16_bf16 v[160:175], v[192:195], v[96:99], v[160:175]
    ds_read_b64_tr_b16 v[0:1], v227 offset:20480
    ds_read_b64_tr_b16 v[2:3], v227 offset:20992
    v_rcp_f32 v210, v210
    v_rcp_f32 v211, v211
    v_mfma_f32_32x32x16_bf16 v[176:191], v[196:199], v[96:99], v[176:191]
    ds_read_b64_tr_b16 v[4:5], v228 offset:20480
    ds_read_b64_tr_b16 v[6:7], v228 offset:20992
    v_mul_f32 v148, v148, v208
    v_mul_f32 v149, v149, v209
    v_mul_f32 v150, v150, v210
    v_mul_f32 v151, v151, v211
    s_waitcnt lgkmcnt(4)
    v_mfma_f32_32x32x16_bf16 v[160:175], v[200:203], v[100:103], v[160:175]
    ds_read_b64_tr_b16 v[192:193], v227 offset:22528
    ds_read_b64_tr_b16 v[194:195], v227 offset:23040
    v_cvt_pk_bf16_f32 v216, v144, v145
    v_cvt_pk_bf16_f32 v217, v146, v147
    v_cvt_pk_bf16_f32 v218, v148, v149
    v_cvt_pk_bf16_f32 v219, v150, v151
    v_mfma_f32_32x32x16_bf16 v[176:191], v[204:207], v[100:103], v[176:191]
    ds_read_b64_tr_b16 v[196:197], v228 offset:22528
    ds_read_b64_tr_b16 v[198:199], v228 offset:23040
    buffer_store_dwordx4 v[216:219], v224, s[44:47], 0 offen offset:0 sc1
    s_mul_i32 s29, s28, 1280
    s_mov_b32 s31, 0
    s_lshl_b32 s31, s31, 6
    s_add_u32 s29, s29, s31
    s_add_u32 s29, s29, 65792
    v_and_b32 v247, 15, v226
    v_lshl_add_u32 v247, v247, 2, s29
    v_bfe_u32 v253, v226, 4, 1
    s_waitcnt lgkmcnt(4)
    v_mfma_f32_32x32x16_bf16 v[160:175], v[0:3], v[104:107], v[160:175]
    v_lshl_add_u32 v247, v253, 9, v247
    buffer_load_dword v231, v247, s[44:47], 0 offen sc1
    s_mul_i32 s29, s28, 1280
    s_mov_b32 s31, 1
    s_lshl_b32 s31, s31, 6
    s_add_u32 s29, s29, s31
    s_add_u32 s29, s29, 65792
    v_and_b32 v247, 15, v226
    v_lshl_add_u32 v247, v247, 2, s29
    v_mfma_f32_32x32x16_bf16 v[176:191], v[4:7], v[104:107], v[176:191]
    v_bfe_u32 v253, v226, 4, 1
    v_lshl_add_u32 v247, v253, 9, v247
    buffer_load_dword v232, v247, s[44:47], 0 offen sc1
    s_waitcnt lgkmcnt(0)
    v_mfma_f32_32x32x16_bf16 v[160:175], v[192:195], v[108:111], v[160:175]
    v_mfma_f32_32x32x16_bf16 v[176:191], v[196:199], v[108:111], v[176:191]
    s_waitcnt vmcnt(3)
    s_setprio 0
    s_waitcnt lgkmcnt(0)
    s_barrier
    s_cmp_lg_u32 s24, 0
    s_cbranch_scc1 L_kvsig_18
    s_add_u32 s29, s28, 0
    s_lshl_b32 s29, s29, 7
    s_add_u32 s29, s29, 86016
    v_mov_b32 v246, s29
    v_mov_b32 v247, 1
    v_cmp_eq_u32 vcc, 0, v226
    s_and_saveexec_b64 s[30:31], vcc
    buffer_atomic_add v247, v246, s[44:47], 0 offen
    s_mov_b64 exec, s[30:31]
L_kvsig_18:
    v_lshrrev_b32 v246, 3, v226
    v_and_b32 v247, 7, v226
    v_bfe_u32 v248, v226, 4, 1
    v_lshlrev_b32 v248, 2, v248
    v_xor_b32 v247, v247, v248
    v_mul_u32_u24 v246, 896, v246
    v_lshl_add_u32 v237, v247, 4, v246
    s_lshl_b32 s29, s71, 7
    s_mul_i32 s30, s25, 7168
    s_add_u32 s29, s29, s30
    s_mul_i32 s35, s26, 544768
    s_cmp_eq_u32 s26, 3
    s_cselect_b32 s35, 0, s35
    s_cselect_b32 s12, s68, s64
    s_cselect_b32 s13, s69, s65
    s_cselect_b32 s36, 3584, 0
    s_mov_b32 s14, 1605632
    s_cselect_b32 s14, 401408, s14
    s_add_u32 s35, s35, s29
    s_and_b32 s13, s13, 0xffff
    s_mov_b32 s15, 0x20000
    s_mul_i32 s37, s26, 38912
    s_lshl_b32 s30, s25, 10
    s_add_u32 s37, s37, s30
    s_lshl_b32 s72, s71, 2
    s_mov_b32 s30, 38
    s_cmp_eq_u32 s26, 2
    s_cselect_b32 s30, 36, s30
    s_sub_u32 s73, s30, s72
    s_mul_i32 s74, s30, 14336
    s_sub_u32 s74, 14336, s74
    s_lshl_b32 s75, s30, 10
    s_sub_u32 s75, 1024, s75
    s_cmp_eq_u32 s26, 3
    s_cselect_b32 s72, 0, s72
    s_cselect_b32 s73, 255, s73
    s_lshl_b32 s76, s72, 10
    s_mul_i32 s29, s72, 14336
    s_add_u32 s38, s35, s29
    s_mov_b32 m0, s37
    s_nop 0
    buffer_load_dwordx4 v237, s[12:15], s38 offen lds
    s_add_u32 m0, m0, 2048
    s_add_u32 s38, s38, 14336
    buffer_load_dwordx4 v237, s[12:15], s38 offen lds
    s_add_u32 m0, m0, 2048
    s_add_u32 s38, s38, 14336
    s_sub_u32 s38, s38, s36
    buffer_load_dwordx4 v237, s[12:15], s38 offen lds
    s_add_u32 m0, m0, 2048
    s_add_u32 s38, s38, 14336
    buffer_load_dwordx4 v237, s[12:15], s38 offen lds
    s_add_u32 m0, m0, 2048
    s_add_u32 s38, s38, 14336
    s_sub_u32 s38, s38, s36
    buffer_load_dwordx4 v237, s[12:15], s38 offen lds
    s_add_u32 m0, m0, 2048
    s_add_u32 s38, s38, 14336
    buffer_load_dwordx4 v237, s[12:15], s38 offen lds
    s_add_u32 m0, m0, 2048
    s_add_u32 s38, s38, 14336
    s_sub_u32 s38, s38, s36
    buffer_load_dwordx4 v237, s[12:15], s38 offen lds
    s_add_u32 m0, m0, 2048
    s_add_u32 s38, s38, 14336
    buffer_load_dwordx4 v237, s[12:15], s38 offen lds
    s_add_u32 m0, m0, 2048
    s_add_u32 s38, s38, 14336
    s_sub_u32 s38, s38, s36
    s_waitcnt vmcnt(8)
    v_cndmask_b32 v231, 0, v231, s[90:91]
    v_and_b32 v246, s3, v231
    v_sub_f32 v231, v231, v246
    v_and_b32 v247, s3, v231
    v_lshrrev_b32 v246, 16, v246
    v_sub_f32 v231, v231, v247
    v_or_b32 v242, v246, v247
    v_lshrrev_b32 v243, 16, v231
    s_nop 1
    v_mfma_f32_32x32x16_bf16 v[160:175], v[242:245], v[238:241], v[160:175]
    v_cndmask_b32 v232, 0, v232, s[90:91]
    v_and_b32 v246, s3, v232
    v_sub_f32 v232, v232, v246
    v_and_b32 v247, s3, v232
    v_lshrrev_b32 v246, 16, v246
    v_sub_f32 v232, v232, v247
    v_or_b32 v242, v246, v247
    v_lshrrev_b32 v243, 16, v232
    s_nop 1
    v_mfma_f32_32x32x16_bf16 v[176:191], v[242:245], v[238:241], v[176:191]
    s_lshl_b32 s29, s25, 11
    s_add_u32 s29, s29, 4096
    v_add_u32 v224, s29, v224
    s_nop 12
    v_pk_mul_f32 v[208:209], v[160:161], v[234:235] op_sel:[0,1] op_sel_hi:[1,1]
    v_pk_mul_f32 v[210:211], v[162:163], v[234:235] op_sel:[0,1] op_sel_hi:[1,1]
    v_pk_mul_f32 v[212:213], v[164:165], v[234:235] op_sel:[0,1] op_sel_hi:[1,1]
    v_pk_mul_f32 v[214:215], v[166:167], v[234:235] op_sel:[0,1] op_sel_hi:[1,1]
    v_exp_f32 v208, v208
    v_exp_f32 v209, v209
    v_exp_f32 v210, v210
    v_exp_f32 v211, v211
    v_exp_f32 v212, v212
    v_exp_f32 v213, v213
    v_exp_f32 v214, v214
    v_exp_f32 v215, v215
    v_pk_mul_f32 v[160:161], v[160:161], v[168:169]
    v_pk_mul_f32 v[162:163], v[162:163], v[170:171]
    v_pk_mul_f32 v[164:165], v[164:165], v[172:173]
    v_pk_mul_f32 v[166:167], v[166:167], v[174:175]
    v_pk_fma_f32 v[208:209], v[208:209], v[236:237], v[236:237] op_sel_hi:[1,0,0]
    v_pk_fma_f32 v[210:211], v[210:211], v[236:237], v[236:237] op_sel_hi:[1,0,0]
    v_pk_fma_f32 v[212:213], v[212:213], v[236:237], v[236:237] op_sel_hi:[1,0,0]
    v_pk_fma_f32 v[214:215], v[214:215], v[236:237], v[236:237] op_sel_hi:[1,0,0]
    v_rcp_f32 v208, v208
    v_rcp_f32 v209, v209
    v_rcp_f32 v210, v210
    v_rcp_f32 v211, v211
    v_rcp_f32 v212, v212
    v_rcp_f32 v213, v213
    v_rcp_f32 v214, v214
    v_rcp_f32 v215, v215
    v_pk_mul_f32 v[160:161], v[160:161], v[208:209]
    v_pk_mul_f32 v[162:163], v[162:163], v[210:211]
    v_pk_mul_f32 v[164:165], v[164:165], v[212:213]
    v_pk_mul_f32 v[166:167], v[166:167], v[214:215]
    v_cvt_pk_bf16_f32 v216, v160, v161
    v_cvt_pk_bf16_f32 v217, v162, v163
    v_cvt_pk_bf16_f32 v218, v164, v165
    v_cvt_pk_bf16_f32 v219, v166, v167
    buffer_store_dwordx4 v[216:219], v224, s[44:47], 0 offen offset:0 sc1
    v_pk_mul_f32 v[208:209], v[176:177], v[234:235] op_sel:[0,1] op_sel_hi:[1,1]
    v_pk_mul_f32 v[210:211], v[178:179], v[234:235] op_sel:[0,1] op_sel_hi:[1,1]
    v_pk_mul_f32 v[212:213], v[180:181], v[234:235] op_sel:[0,1] op_sel_hi:[1,1]
    v_pk_mul_f32 v[214:215], v[182:183], v[234:235] op_sel:[0,1] op_sel_hi:[1,1]
    v_exp_f32 v208, v208
    v_exp_f32 v209, v209
    v_exp_f32 v210, v210
    v_exp_f32 v211, v211
    v_exp_f32 v212, v212
    v_exp_f32 v213, v213
    v_exp_f32 v214, v214
    v_exp_f32 v215, v215
    v_pk_mul_f32 v[176:177], v[176:177], v[184:185]
    v_pk_mul_f32 v[178:179], v[178:179], v[186:187]
    v_pk_mul_f32 v[180:181], v[180:181], v[188:189]
    v_pk_mul_f32 v[182:183], v[182:183], v[190:191]
    v_pk_fma_f32 v[208:209], v[208:209], v[236:237], v[236:237] op_sel_hi:[1,0,0]
    v_pk_fma_f32 v[210:211], v[210:211], v[236:237], v[236:237] op_sel_hi:[1,0,0]
    v_pk_fma_f32 v[212:213], v[212:213], v[236:237], v[236:237] op_sel_hi:[1,0,0]
    v_pk_fma_f32 v[214:215], v[214:215], v[236:237], v[236:237] op_sel_hi:[1,0,0]
    v_rcp_f32 v208, v208
    v_rcp_f32 v209, v209
    v_rcp_f32 v210, v210
    v_rcp_f32 v211, v211
    v_rcp_f32 v212, v212
    v_rcp_f32 v213, v213
    v_rcp_f32 v214, v214
    v_rcp_f32 v215, v215
    v_pk_mul_f32 v[176:177], v[176:177], v[208:209]
    v_pk_mul_f32 v[178:179], v[178:179], v[210:211]
    v_pk_mul_f32 v[180:181], v[180:181], v[212:213]
    v_pk_mul_f32 v[182:183], v[182:183], v[214:215]
    v_cvt_pk_bf16_f32 v216, v176, v177
    v_cvt_pk_bf16_f32 v217, v178, v179
    v_cvt_pk_bf16_f32 v218, v180, v181
    v_cvt_pk_bf16_f32 v219, v182, v183
    buffer_store_dwordx4 v[216:219], v224, s[44:47], 0 offen offset:1024 sc1
    buffer_load_dwordx4 v237, s[12:15], s38 offen lds
    s_add_u32 m0, m0, 2048
    s_add_u32 s38, s38, 14336
    buffer_load_dwordx4 v237, s[12:15], s38 offen lds
    s_add_u32 m0, m0, 2048
    s_add_u32 s38, s38, 14336
    s_sub_u32 s38, s38, s36
    buffer_load_dwordx4 v237, s[12:15], s38 offen lds
    s_add_u32 m0, m0, 2048
    s_add_u32 s38, s38, 14336
    buffer_load_dwordx4 v237, s[12:15], s38 offen lds
    s_add_u32 m0, m0, 2048
    s_cmp_eq_u32 s73, 12
    s_cselect_b32 s29, s74, 14336
    s_add_u32 s38, s38, s29
    s_sub_u32 s38, s38, s36
    buffer_load_dwordx4 v237, s[12:15], s38 offen lds
    s_add_u32 m0, m0, 2048
    s_cmp_eq_u32 s73, 13
    s_cselect_b32 s29, s74, 14336
    s_add_u32 s38, s38, s29
    buffer_load_dwordx4 v237, s[12:15], s38 offen lds
    s_add_u32 m0, m0, 2048
    s_cmp_eq_u32 s73, 14
    s_cselect_b32 s29, s74, 14336
    s_add_u32 s38, s38, s29
    s_sub_u32 s38, s38, s36
    buffer_load_dwordx4 v237, s[12:15], s38 offen lds
    s_add_u32 m0, m0, 2048
    s_cmp_eq_u32 s73, 15
    s_cselect_b32 s29, s74, 14336
    s_add_u32 s38, s38, s29
    buffer_load_dwordx4 v237, s[12:15], s38 offen lds
    s_add_u32 m0, m0, 2048
    s_cmp_eq_u32 s73, 16
    s_cselect_b32 s29, s74, 14336
    s_add_u32 s38, s38, s29
    s_sub_u32 s38, s38, s36
    buffer_load_dwordx4 v237, s[12:15], s38 offen lds
    s_add_u32 m0, m0, 2048
    s_cmp_eq_u32 s73, 17
    s_cselect_b32 s29, s74, 14336
    s_add_u32 s38, s38, s29
    buffer_load_dwordx4 v237, s[12:15], s38 offen lds
    s_add_u32 m0, m0, 2048
    s_cmp_eq_u32 s73, 18
    s_cselect_b32 s29, s74, 14336
    s_add_u32 s38, s38, s29
    s_sub_u32 s38, s38, s36
    buffer_load_dwordx4 v237, s[12:15], s38 offen lds
    s_add_u32 m0, m0, 2048
    s_cmp_eq_u32 s73, 19
    s_cselect_b32 s29, s74, 14336
    s_add_u32 s38, s38, s29
    s_mov_b32 s16, s66
    s_and_b32 s17, s67, 0xffff
    s_mov_b32 s18, 1835008
    s_mov_b32 s19, 0x20000
    s_mov_b32 s20, s4
    s_and_b32 s21, s5, 0xffff
    s_mov_b32 s22, 1835008
    s_mov_b32 s23, 0x20000
    v_lshrrev_b32 v240, 5, v226
    v_lshlrev_b32 v240, 2, v240
    v_bfe_u32 v241, v226, 2, 2
    v_add_u32 v240, v240, v241
    v_lshlrev_b32 v240, 7, v240
    v_bfe_u32 v241, v226, 4, 1
    v_lshl_add_u32 v240, v241, 5, v240
    v_and_b32 v241, 3, v226
    v_lshl_add_u32 v240, v241, 3, v240
    v_bfe_u32 v241, v226, 3, 1
    v_lshl_add_u32 v232, v241, 6, v240
    v_xor_b32 v241, 1, v241
    v_lshl_add_u32 v233, v241, 6, v240
    s_mul_i32 s29, s26, 38912
    v_add_u32 v232, s29, v232
    v_add_u32 v233, s29, v233
    s_lshl_b32 s29, s70, 1
    s_add_u32 s29, s29, s25
    s_mul_i32 s29, s29, 144
    s_mul_i32 s30, s26, 38
    s_cmp_eq_u32 s26, 3
    s_cselect_b32 s30, 112, s30
    s_add_u32 s29, s29, s30
    s_lshl_b32 s29, s29, 10
    s_add_u32 s29, s29, 1048576
    v_lshlrev_b32 v240, 4, v226
    v_add_u32 v234, s29, v240
    s_lshl_b32 s29, s25, 15
    v_add_u32 v236, s29, v240
    s_lshl_b32 s29, s70, 6
    s_lshl_b32 s30, s25, 5
    s_add_u32 s29, s29, s30
    v_and_b32 v240, 31, v226
    v_add_u32 v240, s29, v240
    v_mul_u32_u24 v240, 896, v240
    s_lshl_b32 s29, s71, 7
    s_lshl_b32 s30, s26, 5
    s_add_u32 s29, s29, s30
    v_add_u32 v240, s29, v240
    v_lshrrev_b32 v241, 5, v226
    v_lshl_add_u32 v235, v241, 3, v240
    s_waitcnt vmcnt(0)
    s_barrier
    s_cmp_lg_u32 s24, 0
    s_cbranch_scc1 L_hsig_19
    s_add_u32 s29, s27, 16
    s_lshl_b32 s29, s29, 7
    s_add_u32 s29, s29, 86016
    v_mov_b32 v246, s29
    v_mov_b32 v247, 1
    v_cmp_eq_u32 vcc, 0, v226
    s_and_saveexec_b64 s[30:31], vcc
    buffer_atomic_add v247, v246, s[44:47], 0 offen
    s_mov_b64 exec, s[30:31]
L_hsig_19:
    s_branch L_g2_20
L_go_slow_11:
    s_mov_b32 s31, 0
L_go_100011:
    buffer_load_dword v251, v241, s[52:55], 0 offen sc1
    s_add_u32 s31, s31, 1
    s_waitcnt vmcnt(0)
    v_cmp_gt_u32 vcc, 8, v251
    s_nop 4
    s_cmp_gt_u32 s31, 400000
    s_cbranch_scc1 L_go_done_100012
    s_cbranch_vccz L_go_done_100012
    s_sleep 1
    s_branch L_go_100011
L_go_done_100012:
    s_branch L_go_back_12
L_prew_slow_15:
    s_mov_b32 s31, 0
L_pre_100021:
    buffer_load_dword v254, v253, s[44:47], 0 offen sc1
    s_add_u32 s31, s31, 1
    s_waitcnt vmcnt(0)
    v_cmp_gt_u32 vcc, 16, v254
    s_nop 4
    s_cmp_gt_u32 s31, 400000
    s_cbranch_scc1 L_pre_done_100022
    s_cbranch_vccz L_pre_done_100022
    s_sleep 1
    s_branch L_pre_100021
L_pre_done_100022:
    s_branch L_prew_back_16
L_g1_A_17:
    ds_read_b64_tr_b16 v[192:193], v227 offset:16384
    ds_read_b64_tr_b16 v[194:195], v227 offset:16896
    ds_read_b64_tr_b16 v[196:197], v228 offset:16384
    ds_read_b64_tr_b16 v[198:199], v228 offset:16896
    ds_read_b64_tr_b16 v[200:201], v227 offset:18432
    ds_read_b64_tr_b16 v[202:203], v227 offset:18944
    ds_read_b64_tr_b16 v[204:205], v228 offset:18432
    ds_read_b64_tr_b16 v[206:207], v228 offset:18944
    s_waitcnt lgkmcnt(4)
    v_mfma_f32_32x32x16_bf16 v[160:175], v[192:195], v[0:3], 0
    s_waitcnt vmcnt(6)
    v_xor_b32 v246, 0x8000, v235
    v_mul_f32 v236, v234, v234
    v_rcp_f32 v234, v234
    v_lshl_or_b32 v238, v246, 16, v246
    v_mov_b32 v239, v246
    v_mov_b32 v240, 0
    v_mov_b32 v241, 0
    v_mfma_f32_32x32x16_bf16 v[176:191], v[196:199], v[0:3], 0
    v_mov_b32 v244, 0
    v_mov_b32 v245, 0
    s_mov_b32 s29, 3216550459
    v_mul_f32 v235, s29, v234
    v_mov_b32 v254, 3049366176
    v_mov_b32 v255, s33
    s_lshl_b32 s29, s26, 7
    s_add_u32 s29, s29, 149504
    v_and_b32 v252, 31, v226
    v_lshl_add_u32 v252, v252, 2, s29
    ds_write_b32 v252, v234
    s_waitcnt lgkmcnt(1)
    v_mfma_f32_32x32x16_bf16 v[160:175], v[200:203], v[4:7], v[160:175]
    ds_read_b64_tr_b16 v[192:193], v227 offset:22528
    ds_read_b64_tr_b16 v[194:195], v227 offset:23040
    v_lshrrev_b32 v253, 5, v226
    v_lshl_add_u32 v253, v253, 4, s29
    v_cndmask_b32 v231, 0, v231, s[90:91]
    v_and_b32 v246, s3, v231
    v_sub_f32 v231, v231, v246
    v_and_b32 v247, s3, v231
    v_lshrrev_b32 v246, 16, v246
    v_sub_f32 v231, v231, v247
    v_mfma_f32_32x32x16_bf16 v[176:191], v[204:207], v[4:7], v[176:191]
    ds_read_b64_tr_b16 v[196:197], v228 offset:22528
    ds_read_b64_tr_b16 v[198:199], v228 offset:23040
    v_or_b32 v242, v246, v247
    v_lshrrev_b32 v243, 16, v231
    s_nop 1
    v_mfma_f32_32x32x16_bf16 v[112:127], v[238:241], v[242:245], v[112:127]
    s_waitcnt lgkmcnt(4)
    ds_read_b128 v[208:211], v253 offset:0
    ds_read_b128 v[212:215], v253 offset:32
    v_cndmask_b32 v232, 0, v232, s[90:91]
    v_and_b32 v246, s3, v232
    ds_read_b64_tr_b16 v[0:1], v227 offset:20480
    ds_read_b64_tr_b16 v[2:3], v227 offset:20992
    ds_read_b64_tr_b16 v[4:5], v228 offset:20480
    ds_read_b64_tr_b16 v[6:7], v228 offset:20992
    s_waitcnt lgkmcnt(0)
    v_mfma_f32_32x32x16_bf16 v[160:175], v[0:3], v[8:11], v[160:175]
    s_waitcnt lgkmcnt(0)
    s_waitcnt vmcnt(4)
    s_barrier
    ds_read_b64_tr_b16 v[200:201], v227 offset:32768
    ds_read_b64_tr_b16 v[202:203], v227 offset:33280
    v_sub_f32 v232, v232, v246
    v_and_b32 v247, s3, v232
    v_lshrrev_b32 v246, 16, v246
    v_sub_f32 v232, v232, v247
    v_or_b32 v242, v246, v247
    v_lshrrev_b32 v243, 16, v232
    s_nop 1
    v_mfma_f32_32x32x16_bf16 v[128:143], v[238:241], v[242:245], v[128:143]
    v_mfma_f32_32x32x16_bf16 v[176:191], v[4:7], v[8:11], v[176:191]
    ds_read_b64_tr_b16 v[204:205], v228 offset:32768
    ds_read_b64_tr_b16 v[206:207], v228 offset:33280
    v_cndmask_b32 v233, 0, v233, s[90:91]
    v_and_b32 v246, s3, v233
    v_sub_f32 v233, v233, v246
    v_and_b32 v247, s3, v233
    v_lshrrev_b32 v246, 16, v246
    v_sub_f32 v233, v233, v247
    v_or_b32 v242, v246, v247
    v_lshrrev_b32 v243, 16, v233
    s_nop 1
    v_mfma_f32_32x32x16_bf16 v[160:175], v[192:195], v[12:15], v[160:175]
    ds_read_b64_tr_b16 v[0:1], v227 offset:34816
    ds_read_b64_tr_b16 v[2:3], v227 offset:35328
    v_mfma_f32_32x32x16_bf16 v[144:159], v[242:245], v[238:241], v[144:159]
    v_mul_f32 v128, v128, v208
    v_mul_f32 v129, v129, v209
    v_mul_f32 v130, v130, v210
    v_mul_f32 v131, v131, v211
    v_mul_f32 v132, v132, v212
    v_mul_f32 v133, v133, v213
    v_mfma_f32_32x32x16_bf16 v[176:191], v[196:199], v[12:15], v[176:191]
    ds_read_b64_tr_b16 v[4:5], v228 offset:34816
    ds_read_b64_tr_b16 v[6:7], v228 offset:35328
    v_mul_f32 v134, v134, v214
    v_mul_f32 v135, v135, v215
    v_fma_f32 v112, v112, v208, v255
    v_fma_f32 v113, v113, v209, v255
    v_fma_f32 v114, v114, v210, v255
    v_fma_f32 v115, v115, v211, v255
    v_fma_f32 v116, v116, v212, v255
    v_fma_f32 v117, v117, v213, v255
    s_add_u32 m0, s62, 65536
    s_nop 0
    buffer_load_dwordx4 v229, s[16:19], s82 offen lds
    s_add_u32 m0, s62, 73728
    s_nop 0
    buffer_load_dwordx4 v230, s[20:23], s82 offen lds
    s_waitcnt lgkmcnt(4)
    v_mfma_f32_32x32x16_bf16 v[160:175], v[200:203], v[16:19], v[160:175]
    ds_read_b64_tr_b16 v[192:193], v227 offset:36864
    ds_read_b64_tr_b16 v[194:195], v227 offset:37376
    v_fma_f32 v118, v118, v214, v255
    v_fma_f32 v119, v119, v215, v255
    v_fma_f32 v216, v112, s93, v254
    v_fma_f32 v217, v113, s93, v254
    v_fma_f32 v218, v114, s93, v254
    v_fma_f32 v219, v115, s93, v254
    v_fma_f32 v220, v116, s93, v254
    v_fma_f32 v221, v117, s93, v254
    v_mfma_f32_32x32x16_bf16 v[176:191], v[204:207], v[16:19], v[176:191]
    ds_read_b64_tr_b16 v[196:197], v228 offset:36864
    ds_read_b64_tr_b16 v[198:199], v228 offset:37376
    v_fma_f32 v222, v118, s93, v254
    v_fma_f32 v223, v119, s93, v254
    v_exp_f32_e64 v216, v216 clamp
    v_exp_f32_e64 v217, v217 clamp
    v_exp_f32_e64 v218, v218 clamp
    buffer_load_dword v237, v225, s[40:43], s60 offen
    s_add_u32 s60, s60, 57344
    buffer_load_dword v237, v225, s[40:43], s60 offen
    s_add_u32 s60, s60, 57344
    s_waitcnt lgkmcnt(4)
    v_mfma_f32_32x32x16_bf16 v[160:175], v[0:3], v[20:23], v[160:175]
    ds_read_b64_tr_b16 v[200:201], v227 offset:38912
    ds_read_b64_tr_b16 v[202:203], v227 offset:39424
    v_exp_f32_e64 v219, v219 clamp
    v_exp_f32_e64 v220, v220 clamp
    v_exp_f32_e64 v221, v221 clamp
    v_exp_f32_e64 v222, v222 clamp
    v_mfma_f32_32x32x16_bf16 v[176:191], v[4:7], v[20:23], v[176:191]
    ds_read_b64_tr_b16 v[204:205], v228 offset:38912
    ds_read_b64_tr_b16 v[206:207], v228 offset:39424
    v_exp_f32_e64 v223, v223 clamp
    v_max_f32 v112, s33, v112
    v_max_f32 v113, s33, v113
    v_max_f32 v114, s33, v114
    v_max_f32 v115, s33, v115
    v_max_f32 v116, s33, v116
    v_max_f32 v117, s33, v117
    s_waitcnt lgkmcnt(4)
    v_mfma_f32_32x32x16_bf16 v[160:175], v[192:195], v[24:27], v[160:175]
    s_waitcnt lgkmcnt(0)
    s_waitcnt vmcnt(5)
    s_barrier
    ds_read_b64_tr_b16 v[0:1], v227 offset:0
    ds_read_b64_tr_b16 v[2:3], v227 offset:512
    v_max_f32 v118, s33, v118
    v_max_f32 v119, s33, v119
    v_add_f32 v112, v112, v216
    v_add_f32 v113, v113, v217
    v_add_f32 v114, v114, v218
    v_add_f32 v115, v115, v219
    v_add_f32 v116, v116, v220
    v_add_f32 v117, v117, v221
    v_mfma_f32_32x32x16_bf16 v[176:191], v[196:199], v[24:27], v[176:191]
    ds_read_b64_tr_b16 v[4:5], v228 offset:0
    ds_read_b64_tr_b16 v[6:7], v228 offset:512
    v_add_f32 v118, v118, v222
    v_add_f32 v119, v119, v223
    v_cvt_pk_bf16_f32 v112, v112, v113
    v_cvt_pk_bf16_f32 v113, v114, v115
    v_cvt_pk_bf16_f32 v114, v116, v117
    v_cvt_pk_bf16_f32 v115, v118, v119
    v_cvt_pk_bf16_f32 v128, v128, v129
    v_cvt_pk_bf16_f32 v129, v130, v131
    v_mfma_f32_32x32x16_bf16 v[160:175], v[200:203], v[28:31], v[160:175]
    ds_read_b64_tr_b16 v[192:193], v227 offset:2048
    ds_read_b64_tr_b16 v[194:195], v227 offset:2560
    v_cvt_pk_bf16_f32 v130, v132, v133
    v_cvt_pk_bf16_f32 v131, v134, v135
    ds_read_b128 v[208:211], v253 offset:64
    ds_read_b128 v[212:215], v253 offset:96
    v_and_b32 v246, 31, v226
    s_lshr_b32 s29, s35, 1
    v_subrev_u32 v247, s29, v246
    s_cmp_eq_u32 s35, 0
    s_cselect_b32 s30, 28, 0
    v_cmp_eq_u32 s[30:31], s30, v246
    v_mov_b32 v248, 0
    v_mfma_f32_32x32x16_bf16 v[176:191], v[204:207], v[28:31], v[176:191]
    ds_read_b64_tr_b16 v[196:197], v228 offset:2048
    ds_read_b64_tr_b16 v[198:199], v228 offset:2560
    v_mov_b32 v249, s63
    v_cndmask_b32 v248, v248, v249, s[30:31]
    v_mov_b32 v249, 0
    s_waitcnt lgkmcnt(2)
    v_mul_f32 v136, v136, v208
    v_mul_f32 v137, v137, v209
    v_mul_f32 v138, v138, v210
    v_mul_f32 v139, v139, v211
    v_mul_f32 v140, v140, v212
    s_add_u32 m0, s62, 81920
    s_nop 0
    buffer_load_dwordx4 v229, s[16:19], s83 offen lds
    s_add_u32 m0, s62, 90112
    s_nop 0
    buffer_load_dwordx4 v230, s[20:23], s83 offen lds
    v_mfma_f32_32x32x16_bf16 v[160:175], v[0:3], v[32:35], v[160:175]
    ds_read_b64_tr_b16 v[200:201], v227 offset:4096
    ds_read_b64_tr_b16 v[202:203], v227 offset:4608
    v_mul_f32 v141, v141, v213
    v_mul_f32 v142, v142, v214
    v_mul_f32 v143, v143, v215
    v_fma_f32 v120, v120, v208, v255
    v_fma_f32 v121, v121, v209, v255
    v_fma_f32 v122, v122, v210, v255
    v_fma_f32 v123, v123, v211, v255
    v_fma_f32 v124, v124, v212, v255
    v_mfma_f32_32x32x16_bf16 v[176:191], v[4:7], v[32:35], v[176:191]
    ds_read_b64_tr_b16 v[204:205], v228 offset:4096
    ds_read_b64_tr_b16 v[206:207], v228 offset:4608
    v_fma_f32 v125, v125, v213, v255
    v_fma_f32 v126, v126, v214, v255
    v_fma_f32 v127, v127, v215, v255
    v_fma_f32 v216, v120, s93, v254
    v_fma_f32 v217, v121, s93, v254
    v_fma_f32 v218, v122, s93, v254
    v_fma_f32 v219, v123, s93, v254
    v_fma_f32 v220, v124, s93, v254
    buffer_load_dword v237, v225, s[40:43], s60 offen
    s_add_u32 s60, s60, 57344
    buffer_load_dword v237, v225, s[40:43], s60 offen
    s_add_u32 s60, s60, 57344
    s_waitcnt lgkmcnt(4)
    v_mfma_f32_32x32x16_bf16 v[160:175], v[192:195], v[36:39], v[160:175]
    ds_read_b64_tr_b16 v[0:1], v227 offset:6144
    ds_read_b64_tr_b16 v[2:3], v227 offset:6656
    v_fma_f32 v221, v125, s93, v254
    v_fma_f32 v222, v126, s93, v254
    v_fma_f32 v223, v127, s93, v254
    v_exp_f32_e64 v216, v216 clamp
    v_exp_f32_e64 v217, v217 clamp
    v_exp_f32_e64 v218, v218 clamp
    v_mfma_f32_32x32x16_bf16 v[176:191], v[196:199], v[36:39], v[176:191]
    ds_read_b64_tr_b16 v[4:5], v228 offset:6144
    ds_read_b64_tr_b16 v[6:7], v228 offset:6656
    v_exp_f32_e64 v219, v219 clamp
    v_exp_f32_e64 v220, v220 clamp
    v_exp_f32_e64 v221, v221 clamp
    v_exp_f32_e64 v222, v222 clamp
    s_waitcnt lgkmcnt(4)
    v_mfma_f32_32x32x16_bf16 v[160:175], v[200:203], v[40:43], v[160:175]
    s_waitcnt lgkmcnt(0)
    s_waitcnt vmcnt(6)
    s_barrier
    ds_read_b64_tr_b16 v[192:193], v227 offset:16384
    ds_read_b64_tr_b16 v[194:195], v227 offset:16896
    v_exp_f32_e64 v223, v223 clamp
    v_max_f32 v120, s33, v120
    v_max_f32 v121, s33, v121
    v_max_f32 v122, s33, v122
    v_max_f32 v123, s33, v123
    v_max_f32 v124, s33, v124
    v_max_f32 v125, s33, v125
    v_mfma_f32_32x32x16_bf16 v[176:191], v[204:207], v[40:43], v[176:191]
    ds_read_b64_tr_b16 v[196:197], v228 offset:16384
    ds_read_b64_tr_b16 v[198:199], v228 offset:16896
    v_max_f32 v126, s33, v126
    v_max_f32 v127, s33, v127
    v_add_f32 v120, v120, v216
    v_add_f32 v121, v121, v217
    v_add_f32 v122, v122, v218
    v_add_f32 v123, v123, v219
    v_add_f32 v124, v124, v220
    v_add_f32 v125, v125, v221
    v_mfma_f32_32x32x16_bf16 v[160:175], v[0:3], v[44:47], v[160:175]
    ds_read_b64_tr_b16 v[200:201], v227 offset:18432
    ds_read_b64_tr_b16 v[202:203], v227 offset:18944
    v_add_f32 v126, v126, v222
    v_add_f32 v127, v127, v223
    v_cvt_pk_bf16_f32 v116, v120, v121
    v_cvt_pk_bf16_f32 v117, v122, v123
    v_cvt_pk_bf16_f32 v118, v124, v125
    v_cvt_pk_bf16_f32 v119, v126, v127
    v_cvt_pk_bf16_f32 v132, v136, v137
    v_cvt_pk_bf16_f32 v133, v138, v139
    v_mfma_f32_32x32x16_bf16 v[176:191], v[4:7], v[44:47], v[176:191]
    ds_read_b64_tr_b16 v[204:205], v228 offset:18432
    ds_read_b64_tr_b16 v[206:207], v228 offset:18944
    v_cvt_pk_bf16_f32 v134, v140, v141
    v_cvt_pk_bf16_f32 v135, v142, v143
    v_cmp_gt_u32 vcc, 28, v247
    s_nop 1
    v_cndmask_b32 v112, v249, v112, vcc
    v_cndmask_b32 v128, v248, v128, vcc
    v_cndmask_b32 v113, v249, v113, vcc
    v_cndmask_b32 v129, v248, v129, vcc
    v_cndmask_b32 v114, v249, v114, vcc
    s_add_u32 m0, s62, 49152
    s_nop 0
    buffer_load_dwordx4 v229, s[16:19], s84 offen lds
    s_add_u32 m0, s62, 57344
    s_nop 0
    buffer_load_dwordx4 v230, s[20:23], s84 offen lds
    s_waitcnt lgkmcnt(4)
    v_mfma_f32_32x32x16_bf16 v[160:175], v[192:195], v[48:51], v[160:175]
    ds_read_b64_tr_b16 v[0:1], v227 offset:20480
    ds_read_b64_tr_b16 v[2:3], v227 offset:20992
    v_cndmask_b32 v130, v248, v130, vcc
    v_cndmask_b32 v115, v249, v115, vcc
    v_cndmask_b32 v131, v248, v131, vcc
    v_cndmask_b32 v116, v249, v116, vcc
    v_cndmask_b32 v132, v248, v132, vcc
    v_cndmask_b32 v117, v249, v117, vcc
    v_cndmask_b32 v133, v248, v133, vcc
    v_cndmask_b32 v118, v249, v118, vcc
    v_mfma_f32_32x32x16_bf16 v[176:191], v[196:199], v[48:51], v[176:191]
    ds_read_b64_tr_b16 v[4:5], v228 offset:20480
    ds_read_b64_tr_b16 v[6:7], v228 offset:20992
    v_cndmask_b32 v134, v248, v134, vcc
    v_cndmask_b32 v119, v249, v119, vcc
    v_cndmask_b32 v135, v248, v135, vcc
    s_nop 1
    v_mfma_f32_32x32x16_bf16 v[208:223], v[112:115], v[128:131], 0
    v_mfma_f32_32x32x16_bf16 v[208:223], v[116:119], v[132:135], v[208:223]
    s_lshl_b32 s29, s26, 12
    s_add_u32 s29, s29, 133120
    v_lshlrev_b32 v246, 4, v226
    buffer_load_dword v237, v225, s[40:43], s60 offen
    s_add_u32 s60, s60, 57344
    s_waitcnt lgkmcnt(4)
    v_mfma_f32_32x32x16_bf16 v[160:175], v[200:203], v[52:55], v[160:175]
    ds_read_b64_tr_b16 v[192:193], v227 offset:22528
    ds_read_b64_tr_b16 v[194:195], v227 offset:23040
    v_add_u32 v246, s29, v246
    s_nop 13
    ds_write_b128 v246, v[208:211] offset:0
    ds_write_b128 v246, v[212:215] offset:1024
    ds_write_b128 v246, v[216:219] offset:2048
    ds_write_b128 v246, v[220:223] offset:3072
    v_mfma_f32_32x32x16_bf16 v[176:191], v[204:207], v[52:55], v[176:191]
    ds_read_b64_tr_b16 v[196:197], v228 offset:22528
    ds_read_b64_tr_b16 v[198:199], v228 offset:23040
    s_waitcnt lgkmcnt(8)
    v_mfma_f32_32x32x16_bf16 v[160:175], v[0:3], v[56:59], v[160:175]
    s_waitcnt lgkmcnt(0)
    s_waitcnt vmcnt(5)
    s_barrier
    ds_read_b64_tr_b16 v[200:201], v227 offset:32768
    ds_read_b64_tr_b16 v[202:203], v227 offset:33280
    s_lshl_b32 s29, s26, 10
    s_add_u32 s29, s29, 133120
    v_lshlrev_b32 v246, 4, v226
    v_add_u32 v246, s29, v246
    ds_read_b128 v[128:131], v246 offset:0
    ds_read_b128 v[132:135], v246 offset:4096
    ds_read_b128 v[136:139], v246 offset:8192
    ds_read_b128 v[140:143], v246 offset:12288
    s_lshl_b32 s29, s28, 12
    s_lshl_b32 s30, s26, 10
    s_add_u32 s29, s29, s30
    s_add_u32 s29, s29, 0
    v_mfma_f32_32x32x16_bf16 v[176:191], v[4:7], v[56:59], v[176:191]
    ds_read_b64_tr_b16 v[204:205], v228 offset:32768
    ds_read_b64_tr_b16 v[206:207], v228 offset:33280
    v_lshlrev_b32 v251, 2, v226
    v_add_u32 v251, s29, v251
    v_fma_f32 v144, v144, v234, v255
    v_fma_f32 v145, v145, v234, v255
    v_fma_f32 v146, v146, v234, v255
    v_fma_f32 v147, v147, v234, v255
    v_mfma_f32_32x32x16_bf16 v[160:175], v[192:195], v[60:63], v[160:175]
    ds_read_b64_tr_b16 v[0:1], v227 offset:34816
    ds_read_b64_tr_b16 v[2:3], v227 offset:35328
    v_fma_f32 v148, v148, v234, v255
    v_fma_f32 v149, v149, v234, v255
    v_fma_f32 v150, v150, v234, v255
    v_fma_f32 v151, v151, v234, v255
    v_fma_f32 v208, v144, s93, v254
    v_fma_f32 v209, v145, s93, v254
    v_mfma_f32_32x32x16_bf16 v[176:191], v[196:199], v[60:63], v[176:191]
    ds_read_b64_tr_b16 v[4:5], v228 offset:34816
    ds_read_b64_tr_b16 v[6:7], v228 offset:35328
    v_fma_f32 v210, v146, s93, v254
    v_fma_f32 v211, v147, s93, v254
    v_fma_f32 v212, v148, s93, v254
    v_fma_f32 v213, v149, s93, v254
    v_fma_f32 v214, v150, s93, v254
    v_fma_f32 v215, v151, s93, v254
    s_add_u32 m0, s62, 65536
    s_nop 0
    buffer_load_dwordx4 v229, s[16:19], s85 offen lds
    s_add_u32 m0, s62, 73728
    s_nop 0
    buffer_load_dwordx4 v230, s[20:23], s85 offen lds
    s_waitcnt lgkmcnt(4)
    v_mfma_f32_32x32x16_bf16 v[160:175], v[200:203], v[64:67], v[160:175]
    ds_read_b64_tr_b16 v[192:193], v227 offset:36864
    ds_read_b64_tr_b16 v[194:195], v227 offset:37376
    v_exp_f32_e64 v208, v208 clamp
    v_exp_f32_e64 v209, v209 clamp
    v_exp_f32_e64 v210, v210 clamp
    v_mfma_f32_32x32x16_bf16 v[176:191], v[204:207], v[64:67], v[176:191]
    ds_read_b64_tr_b16 v[196:197], v228 offset:36864
    ds_read_b64_tr_b16 v[198:199], v228 offset:37376
    v_exp_f32_e64 v211, v211 clamp
    v_exp_f32_e64 v212, v212 clamp
    v_exp_f32_e64 v213, v213 clamp
    s_mov_b32 s40, s68
    s_and_b32 s41, s69, 0xffff
    s_mov_b32 s42, 401408
    s_and_b32 s10, s70, 3
    s_mul_i32 s10, s10, 112
    s_lshl_b32 s11, s24, 3
    s_add_u32 s10, s10, s11
    s_mul_i32 s10, s10, 896
    s_lshl_b32 s11, s71, 7
    s_add_u32 s10, s10, s11
    s_lshl_b32 s11, s34, 30
    s_add_u32 s60, s10, s11
    buffer_load_dword v237, v225, s[40:43], s60 offen
    s_add_u32 s60, s60, 57344
    s_waitcnt lgkmcnt(4)
    v_mfma_f32_32x32x16_bf16 v[160:175], v[0:3], v[68:71], v[160:175]
    ds_read_b64_tr_b16 v[200:201], v227 offset:38912
    ds_read_b64_tr_b16 v[202:203], v227 offset:39424
    v_exp_f32_e64 v214, v214 clamp
    v_exp_f32_e64 v215, v215 clamp
    v_max_f32 v144, s33, v144
    v_max_f32 v145, s33, v145
    v_mfma_f32_32x32x16_bf16 v[176:191], v[4:7], v[68:71], v[176:191]
    ds_read_b64_tr_b16 v[204:205], v228 offset:38912
    ds_read_b64_tr_b16 v[206:207], v228 offset:39424
    v_max_f32 v146, s33, v146
    v_max_f32 v147, s33, v147
    v_max_f32 v148, s33, v148
    v_max_f32 v149, s33, v149
    v_max_f32 v150, s33, v150
    v_max_f32 v151, s33, v151
    s_waitcnt lgkmcnt(4)
    v_mfma_f32_32x32x16_bf16 v[160:175], v[192:195], v[72:75], v[160:175]
    s_waitcnt lgkmcnt(0)
    s_waitcnt vmcnt(4)
    s_barrier
    ds_read_b64_tr_b16 v[0:1], v227 offset:0
    ds_read_b64_tr_b16 v[2:3], v227 offset:512
    v_add_f32 v144, v144, v208
    v_add_f32 v145, v145, v209
    v_add_f32 v146, v146, v210
    v_add_f32 v147, v147, v211
    v_add_f32 v148, v148, v212
    v_add_f32 v149, v149, v213
    v_mfma_f32_32x32x16_bf16 v[176:191], v[196:199], v[72:75], v[176:191]
    ds_read_b64_tr_b16 v[4:5], v228 offset:0
    ds_read_b64_tr_b16 v[6:7], v228 offset:512
    v_add_f32 v150, v150, v214
    v_add_f32 v151, v151, v215
    v_cvt_pk_bf16_f32 v220, v144, v145
    v_cvt_pk_bf16_f32 v221, v146, v147
    v_cvt_pk_bf16_f32 v222, v148, v149
    v_cvt_pk_bf16_f32 v223, v150, v151
    v_mfma_f32_32x32x16_bf16 v[160:175], v[200:203], v[76:79], v[160:175]
    ds_read_b64_tr_b16 v[192:193], v227 offset:2048
    ds_read_b64_tr_b16 v[194:195], v227 offset:2560
    v_add_f32 v128, v128, v132
    v_add_f32 v136, v136, v140
    v_add_f32 v129, v129, v133
    v_add_f32 v137, v137, v141
    v_add_f32 v130, v130, v134
    v_add_f32 v138, v138, v142
    v_mfma_f32_32x32x16_bf16 v[176:191], v[204:207], v[76:79], v[176:191]
    ds_read_b64_tr_b16 v[196:197], v228 offset:2048
    ds_read_b64_tr_b16 v[198:199], v228 offset:2560
    v_add_f32 v131, v131, v135
    v_add_f32 v139, v139, v143
    v_add_f32 v120, v128, v136
    v_add_f32 v121, v129, v137
    v_add_f32 v122, v130, v138
    v_add_f32 v123, v131, v139
    buffer_load_dword v237, v225, s[40:43], s60 offen
    s_add_u32 s60, s60, 57344
    s_waitcnt lgkmcnt(4)
    v_mfma_f32_32x32x16_bf16 v[160:175], v[0:3], v[80:83], v[160:175]
    ds_read_b64_tr_b16 v[200:201], v227 offset:4096
    ds_read_b64_tr_b16 v[202:203], v227 offset:4608
    buffer_atomic_add_f32 v120, v251, s[44:47], 0 offen offset:0
    buffer_atomic_add_f32 v121, v251, s[44:47], 0 offen offset:256
    buffer_atomic_add_f32 v122, v251, s[44:47], 0 offen offset:512
    buffer_atomic_add_f32 v123, v251, s[44:47], 0 offen offset:768
    v_fma_f32 v152, v152, v234, v255
    v_fma_f32 v153, v153, v234, v255
    v_mfma_f32_32x32x16_bf16 v[176:191], v[4:7], v[80:83], v[176:191]
    ds_read_b64_tr_b16 v[204:205], v228 offset:4096
    ds_read_b64_tr_b16 v[206:207], v228 offset:4608
    v_fma_f32 v154, v154, v234, v255
    v_fma_f32 v155, v155, v234, v255
    v_fma_f32 v156, v156, v234, v255
    v_fma_f32 v157, v157, v234, v255
    v_fma_f32 v158, v158, v234, v255
    v_fma_f32 v159, v159, v234, v255
    s_waitcnt lgkmcnt(4)
    v_mfma_f32_32x32x16_bf16 v[160:175], v[192:195], v[84:87], v[160:175]
    ds_read_b64_tr_b16 v[0:1], v227 offset:6144
    ds_read_b64_tr_b16 v[2:3], v227 offset:6656
    v_fma_f32 v208, v152, s93, v254
    v_fma_f32 v209, v153, s93, v254
    v_fma_f32 v210, v154, s93, v254
    v_fma_f32 v211, v155, s93, v254
    v_fma_f32 v212, v156, s93, v254
    v_fma_f32 v213, v157, s93, v254
    v_mfma_f32_32x32x16_bf16 v[176:191], v[196:199], v[84:87], v[176:191]
    ds_read_b64_tr_b16 v[4:5], v228 offset:6144
    ds_read_b64_tr_b16 v[6:7], v228 offset:6656
    v_fma_f32 v214, v158, s93, v254
    v_fma_f32 v215, v159, s93, v254
    v_exp_f32_e64 v208, v208 clamp
    v_exp_f32_e64 v209, v209 clamp
    s_waitcnt lgkmcnt(4)
    v_mfma_f32_32x32x16_bf16 v[160:175], v[200:203], v[88:91], v[160:175]
    s_waitcnt lgkmcnt(0)
    s_waitcnt vmcnt(6)
    s_barrier
    ds_read_b64_tr_b16 v[192:193], v227 offset:16384
    ds_read_b64_tr_b16 v[194:195], v227 offset:16896
    v_exp_f32_e64 v210, v210 clamp
    v_exp_f32_e64 v211, v211 clamp
    v_exp_f32_e64 v212, v212 clamp
    v_mfma_f32_32x32x16_bf16 v[176:191], v[204:207], v[88:91], v[176:191]
    ds_read_b64_tr_b16 v[196:197], v228 offset:16384
    ds_read_b64_tr_b16 v[198:199], v228 offset:16896
    v_exp_f32_e64 v213, v213 clamp
    v_exp_f32_e64 v214, v214 clamp
    v_exp_f32_e64 v215, v215 clamp
    v_mfma_f32_32x32x16_bf16 v[160:175], v[0:3], v[92:95], v[160:175]
    ds_read_b64_tr_b16 v[200:201], v227 offset:18432
    ds_read_b64_tr_b16 v[202:203], v227 offset:18944
    v_max_f32 v152, s33, v152
    v_max_f32 v153, s33, v153
    v_max_f32 v154, s33, v154
    v_max_f32 v155, s33, v155
    v_max_f32 v156, s33, v156
    v_max_f32 v157, s33, v157
    v_mfma_f32_32x32x16_bf16 v[176:191], v[4:7], v[92:95], v[176:191]
    ds_read_b64_tr_b16 v[204:205], v228 offset:18432
    ds_read_b64_tr_b16 v[206:207], v228 offset:18944
    v_max_f32 v158, s33, v158
    v_max_f32 v159, s33, v159
    v_add_f32 v152, v152, v208
    v_add_f32 v153, v153, v209
    v_add_f32 v154, v154, v210
    v_add_f32 v155, v155, v211
    s_waitcnt lgkmcnt(4)
    v_mfma_f32_32x32x16_bf16 v[160:175], v[192:195], v[96:99], v[160:175]
    ds_read_b64_tr_b16 v[0:1], v227 offset:20480
    ds_read_b64_tr_b16 v[2:3], v227 offset:20992
    v_add_f32 v156, v156, v212
    v_add_f32 v157, v157, v213
    v_add_f32 v158, v158, v214
    v_add_f32 v159, v159, v215
    v_cvt_pk_bf16_f32 v148, v152, v153
    v_cvt_pk_bf16_f32 v149, v154, v155
    v_mfma_f32_32x32x16_bf16 v[176:191], v[196:199], v[96:99], v[176:191]
    ds_read_b64_tr_b16 v[4:5], v228 offset:20480
    ds_read_b64_tr_b16 v[6:7], v228 offset:20992
    v_cvt_pk_bf16_f32 v150, v156, v157
    v_cvt_pk_bf16_f32 v151, v158, v159
    v_mov_b32 v144, v220
    v_mov_b32 v145, v221
    v_mov_b32 v146, v222
    v_mov_b32 v147, v223
    s_mul_i32 s29, s28, 1280
    s_mov_b32 s31, 0
    s_mul_i32 s31, s31, 112
    s_cmp_eq_u32 s31, 336
    s_cselect_b32 s30, 48, 64
    s_cmp_eq_u32 s28, 15
    s_cselect_b32 s30, s30, 0
    s_add_u32 s31, s31, s30
    s_add_u32 s29, s29, s31
    s_add_u32 s29, s29, 66048
    s_waitcnt lgkmcnt(4)
    v_mfma_f32_32x32x16_bf16 v[160:175], v[200:203], v[100:103], v[160:175]
    ds_read_b64_tr_b16 v[192:193], v227 offset:22528
    ds_read_b64_tr_b16 v[194:195], v227 offset:23040
    v_and_b32 v247, 31, v226
    v_lshl_add_u32 v247, v247, 2, s29
    buffer_load_dword v231, v247, s[44:47], 0 offen sc1
    s_mul_i32 s29, s28, 1280
    s_mov_b32 s31, 1
    s_mul_i32 s31, s31, 112
    s_cmp_eq_u32 s31, 336
    s_cselect_b32 s30, 48, 64
    s_cmp_eq_u32 s28, 15
    s_cselect_b32 s30, s30, 0
    s_add_u32 s31, s31, s30
    s_add_u32 s29, s29, s31
    s_add_u32 s29, s29, 66048
    v_and_b32 v247, 31, v226
    v_lshl_add_u32 v247, v247, 2, s29
    buffer_load_dword v232, v247, s[44:47], 0 offen sc1
    v_mfma_f32_32x32x16_bf16 v[176:191], v[204:207], v[100:103], v[176:191]
    ds_read_b64_tr_b16 v[196:197], v228 offset:22528
    ds_read_b64_tr_b16 v[198:199], v228 offset:23040
    s_waitcnt lgkmcnt(4)
    v_mfma_f32_32x32x16_bf16 v[160:175], v[0:3], v[104:107], v[160:175]
    v_mfma_f32_32x32x16_bf16 v[176:191], v[4:7], v[104:107], v[176:191]
    s_waitcnt lgkmcnt(0)
    v_mfma_f32_32x32x16_bf16 v[160:175], v[192:195], v[108:111], v[160:175]
    v_mfma_f32_32x32x16_bf16 v[176:191], v[196:199], v[108:111], v[176:191]
    s_waitcnt vmcnt(2)
    s_setprio 0
    s_waitcnt lgkmcnt(0)
    s_barrier
    s_cmp_lg_u32 s24, 0
    s_cbranch_scc1 L_kvsig_21
    s_add_u32 s29, s28, 0
    s_lshl_b32 s29, s29, 7
    s_add_u32 s29, s29, 86016
    v_mov_b32 v246, s29
    v_mov_b32 v247, 1
    v_cmp_eq_u32 vcc, 0, v226
    s_and_saveexec_b64 s[30:31], vcc
    buffer_atomic_add v247, v246, s[44:47], 0 offen
    s_mov_b64 exec, s[30:31]
L_kvsig_21:
    s_waitcnt vmcnt(0)
    v_cndmask_b32 v231, 0, v231, s[90:91]
    v_and_b32 v246, s3, v231
    v_sub_f32 v231, v231, v246
    v_and_b32 v247, s3, v231
    v_lshrrev_b32 v246, 16, v246
    v_sub_f32 v231, v231, v247
    v_or_b32 v242, v246, v247
    v_lshrrev_b32 v243, 16, v231
    s_nop 1
    v_mfma_f32_32x32x16_bf16 v[160:175], v[242:245], v[238:241], v[160:175]
    v_cndmask_b32 v232, 0, v232, s[90:91]
    v_and_b32 v246, s3, v232
    v_sub_f32 v232, v232, v246
    v_and_b32 v247, s3, v232
    v_lshrrev_b32 v246, 16, v246
    v_sub_f32 v232, v232, v247
    v_or_b32 v242, v246, v247
    v_lshrrev_b32 v243, 16, v232
    s_nop 1
    v_mfma_f32_32x32x16_bf16 v[176:191], v[242:245], v[238:241], v[176:191]
    v_mov_b32 v254, 3049366176
    v_mov_b32 v255, s33
    s_nop 12
    v_fma_f32 v160, v160, v234, v255
    v_fma_f32 v161, v161, v234, v255
    v_fma_f32 v162, v162, v234, v255
    v_fma_f32 v163, v163, v234, v255
    v_fma_f32 v164, v164, v234, v255
    v_fma_f32 v165, v165, v234, v255
    v_fma_f32 v166, v166, v234, v255
    v_fma_f32 v167, v167, v234, v255
    v_fma_f32 v208, v160, s93, v254
    v_fma_f32 v209, v161, s93, v254
    v_fma_f32 v210, v162, s93, v254
    v_fma_f32 v211, v163, s93, v254
    v_fma_f32 v212, v164, s93, v254
    v_fma_f32 v213, v165, s93, v254
    v_fma_f32 v214, v166, s93, v254
    v_fma_f32 v215, v167, s93, v254
    v_exp_f32_e64 v208, v208 clamp
    v_exp_f32_e64 v209, v209 clamp
    v_exp_f32_e64 v210, v210 clamp
    v_exp_f32_e64 v211, v211 clamp
    v_exp_f32_e64 v212, v212 clamp
    v_exp_f32_e64 v213, v213 clamp
    v_exp_f32_e64 v214, v214 clamp
    v_exp_f32_e64 v215, v215 clamp
    v_max_f32 v160, s33, v160
    v_max_f32 v161, s33, v161
    v_max_f32 v162, s33, v162
    v_max_f32 v163, s33, v163
    v_max_f32 v164, s33, v164
    v_max_f32 v165, s33, v165
    v_max_f32 v166, s33, v166
    v_max_f32 v167, s33, v167
    v_add_f32 v160, v160, v208
    v_add_f32 v161, v161, v209
    v_add_f32 v162, v162, v210
    v_add_f32 v163, v163, v211
    v_add_f32 v164, v164, v212
    v_add_f32 v165, v165, v213
    v_add_f32 v166, v166, v214
    v_add_f32 v167, v167, v215
    v_cvt_pk_bf16_f32 v220, v160, v161
    v_cvt_pk_bf16_f32 v221, v162, v163
    v_cvt_pk_bf16_f32 v222, v164, v165
    v_cvt_pk_bf16_f32 v223, v166, v167
    v_fma_f32 v168, v168, v234, v255
    v_fma_f32 v169, v169, v234, v255
    v_fma_f32 v170, v170, v234, v255
    v_fma_f32 v171, v171, v234, v255
    v_fma_f32 v172, v172, v234, v255
    v_fma_f32 v173, v173, v234, v255
    v_fma_f32 v174, v174, v234, v255
    v_fma_f32 v175, v175, v234, v255
    v_fma_f32 v208, v168, s93, v254
    v_fma_f32 v209, v169, s93, v254
    v_fma_f32 v210, v170, s93, v254
    v_fma_f32 v211, v171, s93, v254
    v_fma_f32 v212, v172, s93, v254
    v_fma_f32 v213, v173, s93, v254
    v_fma_f32 v214, v174, s93, v254
    v_fma_f32 v215, v175, s93, v254
    v_exp_f32_e64 v208, v208 clamp
    v_exp_f32_e64 v209, v209 clamp
    v_exp_f32_e64 v210, v210 clamp
    v_exp_f32_e64 v211, v211 clamp
    v_exp_f32_e64 v212, v212 clamp
    v_exp_f32_e64 v213, v213 clamp
    v_exp_f32_e64 v214, v214 clamp
    v_exp_f32_e64 v215, v215 clamp
    v_max_f32 v168, s33, v168
    v_max_f32 v169, s33, v169
    v_max_f32 v170, s33, v170
    v_max_f32 v171, s33, v171
    v_max_f32 v172, s33, v172
    v_max_f32 v173, s33, v173
    v_max_f32 v174, s33, v174
    v_max_f32 v175, s33, v175
    v_add_f32 v168, v168, v208
    v_add_f32 v169, v169, v209
    v_add_f32 v170, v170, v210
    v_add_f32 v171, v171, v211
    v_add_f32 v172, v172, v212
    v_add_f32 v173, v173, v213
    v_add_f32 v174, v174, v214
    v_add_f32 v175, v175, v215
    v_cvt_pk_bf16_f32 v164, v168, v169
    v_cvt_pk_bf16_f32 v165, v170, v171
    v_cvt_pk_bf16_f32 v166, v172, v173
    v_cvt_pk_bf16_f32 v167, v174, v175
    v_mov_b32 v160, v220
    v_mov_b32 v161, v221
    v_mov_b32 v162, v222
    v_mov_b32 v163, v223
    v_fma_f32 v176, v176, v234, v255
    v_fma_f32 v177, v177, v234, v255
    v_fma_f32 v178, v178, v234, v255
    v_fma_f32 v179, v179, v234, v255
    v_fma_f32 v180, v180, v234, v255
    v_fma_f32 v181, v181, v234, v255
    v_fma_f32 v182, v182, v234, v255
    v_fma_f32 v183, v183, v234, v255
    v_fma_f32 v208, v176, s93, v254
    v_fma_f32 v209, v177, s93, v254
    v_fma_f32 v210, v178, s93, v254
    v_fma_f32 v211, v179, s93, v254
    v_fma_f32 v212, v180, s93, v254
    v_fma_f32 v213, v181, s93, v254
    v_fma_f32 v214, v182, s93, v254
    v_fma_f32 v215, v183, s93, v254
    v_exp_f32_e64 v208, v208 clamp
    v_exp_f32_e64 v209, v209 clamp
    v_exp_f32_e64 v210, v210 clamp
    v_exp_f32_e64 v211, v211 clamp
    v_exp_f32_e64 v212, v212 clamp
    v_exp_f32_e64 v213, v213 clamp
    v_exp_f32_e64 v214, v214 clamp
    v_exp_f32_e64 v215, v215 clamp
    v_max_f32 v176, s33, v176
    v_max_f32 v177, s33, v177
    v_max_f32 v178, s33, v178
    v_max_f32 v179, s33, v179
    v_max_f32 v180, s33, v180
    v_max_f32 v181, s33, v181
    v_max_f32 v182, s33, v182
    v_max_f32 v183, s33, v183
    v_add_f32 v176, v176, v208
    v_add_f32 v177, v177, v209
    v_add_f32 v178, v178, v210
    v_add_f32 v179, v179, v211
    v_add_f32 v180, v180, v212
    v_add_f32 v181, v181, v213
    v_add_f32 v182, v182, v214
    v_add_f32 v183, v183, v215
    v_cvt_pk_bf16_f32 v220, v176, v177
    v_cvt_pk_bf16_f32 v221, v178, v179
    v_cvt_pk_bf16_f32 v222, v180, v181
    v_cvt_pk_bf16_f32 v223, v182, v183
    v_fma_f32 v184, v184, v234, v255
    v_fma_f32 v185, v185, v234, v255
    v_fma_f32 v186, v186, v234, v255
    v_fma_f32 v187, v187, v234, v255
    v_fma_f32 v188, v188, v234, v255
    v_fma_f32 v189, v189, v234, v255
    v_fma_f32 v190, v190, v234, v255
    v_fma_f32 v191, v191, v234, v255
    v_fma_f32 v208, v184, s93, v254
    v_fma_f32 v209, v185, s93, v254
    v_fma_f32 v210, v186, s93, v254
    v_fma_f32 v211, v187, s93, v254
    v_fma_f32 v212, v188, s93, v254
    v_fma_f32 v213, v189, s93, v254
    v_fma_f32 v214, v190, s93, v254
    v_fma_f32 v215, v191, s93, v254
    v_exp_f32_e64 v208, v208 clamp
    v_exp_f32_e64 v209, v209 clamp
    v_exp_f32_e64 v210, v210 clamp
    v_exp_f32_e64 v211, v211 clamp
    v_exp_f32_e64 v212, v212 clamp
    v_exp_f32_e64 v213, v213 clamp
    v_exp_f32_e64 v214, v214 clamp
    v_exp_f32_e64 v215, v215 clamp
    v_max_f32 v184, s33, v184
    v_max_f32 v185, s33, v185
    v_max_f32 v186, s33, v186
    v_max_f32 v187, s33, v187
    v_max_f32 v188, s33, v188
    v_max_f32 v189, s33, v189
    v_max_f32 v190, s33, v190
    v_max_f32 v191, s33, v191
    v_add_f32 v184, v184, v208
    v_add_f32 v185, v185, v209
    v_add_f32 v186, v186, v210
    v_add_f32 v187, v187, v211
    v_add_f32 v188, v188, v212
    v_add_f32 v189, v189, v213
    v_add_f32 v190, v190, v214
    v_add_f32 v191, v191, v215
    v_cvt_pk_bf16_f32 v180, v184, v185
    v_cvt_pk_bf16_f32 v181, v186, v187
    v_cvt_pk_bf16_f32 v182, v188, v189
    v_cvt_pk_bf16_f32 v183, v190, v191
    v_mov_b32 v176, v220
    v_mov_b32 v177, v221
    v_mov_b32 v178, v222
    v_mov_b32 v179, v223
    s_sub_u32 s29, s28, 14
    s_lshl_b32 s29, s29, 3
    s_add_u32 s29, s29, 0
    v_and_b32 v246, 7, v226
    v_add_u32 v246, s29, v246
    v_lshlrev_b32 v246, 7, v246
    v_add_u32 v246, 86016, v246
    s_cmp_lg_u32 s24, 0
    s_cbranch_scc1 L_kvpoll_22
    s_mov_b32 s31, 0
L_kvwait_23:
    buffer_load_dword v247, v246, s[44:47], 0 offen sc1
    s_add_u32 s31, s31, 1
    s_waitcnt vmcnt(0)
    v_cmp_gt_u32 vcc, 16, v247
    s_nop 4
    s_cmp_gt_u32 s31, 400000
    s_cbranch_scc1 L_kvwait_done_24
    s_cbranch_vccz L_kvwait_done_24
    s_sleep 1
    s_branch L_kvwait_23
L_kvwait_done_24:
L_kvpoll_22:
    s_barrier
    s_sub_u32 s29, s28, 14
    s_lshl_b32 s29, s29, 3
    s_add_u32 s29, s29, s24
    s_lshl_b32 s29, s29, 12
    s_add_u32 s29, s29, 0
    v_lshlrev_b32 v246, 2, v226
    v_add_u32 v246, s29, v246
    buffer_load_dword v0, v246, s[44:47], 0 offen offset:0 sc1
    buffer_load_dword v1, v246, s[44:47], 0 offen offset:256 sc1
    buffer_load_dword v2, v246, s[44:47], 0 offen offset:512 sc1
    buffer_load_dword v3, v246, s[44:47], 0 offen offset:768 sc1
    buffer_load_dword v4, v246, s[44:47], 0 offen offset:1024 sc1
    buffer_load_dword v5, v246, s[44:47], 0 offen offset:1280 sc1
    buffer_load_dword v6, v246, s[44:47], 0 offen offset:1536 sc1
    buffer_load_dword v7, v246, s[44:47], 0 offen offset:1792 sc1
    buffer_load_dword v8, v246, s[44:47], 0 offen offset:2048 sc1
    buffer_load_dword v9, v246, s[44:47], 0 offen offset:2304 sc1
    buffer_load_dword v10, v246, s[44:47], 0 offen offset:2560 sc1
    buffer_load_dword v11, v246, s[44:47], 0 offen offset:2816 sc1
    buffer_load_dword v12, v246, s[44:47], 0 offen offset:3072 sc1
    buffer_load_dword v13, v246, s[44:47], 0 offen offset:3328 sc1
    buffer_load_dword v14, v246, s[44:47], 0 offen offset:3584 sc1
    buffer_load_dword v15, v246, s[44:47], 0 offen offset:3840 sc1
    s_waitcnt vmcnt(0)
    v_cvt_pk_bf16_f32 v16, v0, v1
    v_cvt_pk_bf16_f32 v17, v2, v3
    v_cvt_pk_bf16_f32 v18, v4, v5
    v_cvt_pk_bf16_f32 v19, v6, v7
    v_cvt_pk_bf16_f32 v20, v8, v9
    v_cvt_pk_bf16_f32 v21, v10, v11
    v_cvt_pk_bf16_f32 v22, v12, v13
    v_cvt_pk_bf16_f32 v23, v14, v15
    s_lshl_b32 s29, s24, 11
    s_add_u32 s29, s29, 147456
    v_lshlrev_b32 v246, 4, v226
    v_add_u32 v246, s29, v246
    ds_write_b128 v246, v[16:19]
    ds_write_b128 v246, v[20:23] offset:1024
    s_waitcnt lgkmcnt(0)
    s_barrier
    v_lshlrev_b32 v246, 4, v226
    v_add_u32 v246, 147456, v246
    ds_read_b128 v[0:3], v246
    ds_read_b128 v[4:7], v246 offset:1024
    s_waitcnt lgkmcnt(0)
    v_mfma_f32_32x32x16_bf16 v[16:31], v[0:3], v[144:147], 0
    v_mfma_f32_32x32x16_bf16 v[16:31], v[4:7], v[148:151], v[16:31]
    s_nop 15
    v_lshlrev_b32 v246, 4, v226
    v_add_u32 v246, 155648, v246
    ds_read_b128 v[8:11], v246
    ds_read_b128 v[12:15], v246 offset:1024
    s_waitcnt lgkmcnt(0)
    v_mfma_f32_32x32x16_bf16 v[48:63], v[8:11], v[160:163], 0
    v_mfma_f32_32x32x16_bf16 v[48:63], v[12:15], v[164:167], v[48:63]
    v_mov_b32 v32, v28
    v_mov_b32 v33, v28
    s_nop 1
    v_permlane32_swap_b32 v32, v33
    s_nop 1
    v_add_f32 v33, 897988541, v33
    v_rcp_f32 v33, v33
    s_nop 0
    v_mul_f32 v16, v16, v33
    v_mul_f32 v17, v17, v33
    v_mul_f32 v18, v18, v33
    v_mul_f32 v19, v19, v33
    v_mul_f32 v20, v20, v33
    v_mul_f32 v21, v21, v33
    v_mul_f32 v22, v22, v33
    v_mul_f32 v23, v23, v33
    v_mul_f32 v24, v24, v33
    v_mul_f32 v25, v25, v33
    v_mul_f32 v26, v26, v33
    v_mul_f32 v27, v27, v33
    v_mul_f32 v28, v28, v33
    v_mul_f32 v29, v29, v33
    v_mul_f32 v30, v30, v33
    v_mul_f32 v31, v31, v33
    v_cvt_pk_bf16_f32 v36, v16, v17
    v_cvt_pk_bf16_f32 v37, v18, v19
    v_cvt_pk_bf16_f32 v38, v20, v21
    v_cvt_pk_bf16_f32 v39, v22, v23
    v_cvt_pk_bf16_f32 v40, v24, v25
    v_cvt_pk_bf16_f32 v41, v26, v27
    v_cvt_pk_bf16_f32 v42, v28, v29
    v_cvt_pk_bf16_f32 v43, v30, v31
    v_cmp_gt_u32 vcc, 32, v226
    v_mov_b32 v32, 0
    s_nop 1
    v_cndmask_b32 v42, v32, v42, vcc
    v_cndmask_b32 v43, v32, v43, vcc
    s_sub_u32 s30, s28, 14
    s_lshl_b32 s30, s30, 4
    s_add_u32 s30, s30, 112
    s_lshl_b32 s29, s27, 2
    s_add_u32 s29, s29, s26
    s_mul_i32 s29, s29, 144
    s_add_u32 s29, s29, s30
    s_lshl_b32 s29, s29, 10
    s_add_u32 s29, s29, 1048576
    v_lshlrev_b32 v246, 4, v226
    v_add_u32 v246, s29, v246
    buffer_store_dwordx4 v[36:39], v246, s[44:47], 0 offen sc1
    buffer_store_dwordx4 v[40:43], v246, s[44:47], 0 offen offset:1024 sc1
    s_nop 1
    v_lshlrev_b32 v246, 4, v226
    v_add_u32 v246, 157696, v246
    ds_read_b128 v[0:3], v246
    ds_read_b128 v[4:7], v246 offset:1024
    s_waitcnt lgkmcnt(0)
    v_mfma_f32_32x32x16_bf16 v[16:31], v[0:3], v[176:179], 0
    v_mfma_f32_32x32x16_bf16 v[16:31], v[4:7], v[180:183], v[16:31]
    v_mov_b32 v32, v60
    v_mov_b32 v33, v60
    s_nop 1
    v_permlane32_swap_b32 v32, v33
    s_nop 1
    v_add_f32 v33, 897988541, v33
    v_rcp_f32 v33, v33
    s_nop 0
    v_mul_f32 v48, v48, v33
    v_mul_f32 v49, v49, v33
    v_mul_f32 v50, v50, v33
    v_mul_f32 v51, v51, v33
    v_mul_f32 v52, v52, v33
    v_mul_f32 v53, v53, v33
    v_mul_f32 v54, v54, v33
    v_mul_f32 v55, v55, v33
    v_mul_f32 v56, v56, v33
    v_mul_f32 v57, v57, v33
    v_mul_f32 v58, v58, v33
    v_mul_f32 v59, v59, v33
    v_mul_f32 v60, v60, v33
    v_mul_f32 v61, v61, v33
    v_mul_f32 v62, v62, v33
    v_mul_f32 v63, v63, v33
    v_cvt_pk_bf16_f32 v36, v48, v49
    v_cvt_pk_bf16_f32 v37, v50, v51
    v_cvt_pk_bf16_f32 v38, v52, v53
    v_cvt_pk_bf16_f32 v39, v54, v55
    v_cvt_pk_bf16_f32 v40, v56, v57
    v_cvt_pk_bf16_f32 v41, v58, v59
    v_cvt_pk_bf16_f32 v42, v60, v61
    v_cvt_pk_bf16_f32 v43, v62, v63
    v_cmp_gt_u32 vcc, 32, v226
    v_mov_b32 v32, 0
    s_nop 1
    v_cndmask_b32 v42, v32, v42, vcc
    v_cndmask_b32 v43, v32, v43, vcc
    s_sub_u32 s30, s28, 14
    s_lshl_b32 s30, s30, 4
    s_add_u32 s30, s30, 120
    s_lshl_b32 s29, s27, 2
    s_add_u32 s29, s29, s26
    s_mul_i32 s29, s29, 144
    s_add_u32 s29, s29, s30
    s_lshl_b32 s29, s29, 10
    s_add_u32 s29, s29, 1048576
    v_lshlrev_b32 v246, 4, v226
    v_add_u32 v246, s29, v246
    buffer_store_dwordx4 v[36:39], v246, s[44:47], 0 offen sc1
    buffer_store_dwordx4 v[40:43], v246, s[44:47], 0 offen offset:1024 sc1
    s_nop 1
    s_nop 7
    v_mov_b32 v32, v28
    v_mov_b32 v33, v28
    s_nop 1
    v_permlane32_swap_b32 v32, v33
    s_nop 1
    v_add_f32 v33, 897988541, v33
    v_rcp_f32 v33, v33
    s_nop 0
    v_mul_f32 v16, v16, v33
    v_mul_f32 v17, v17, v33
    v_mul_f32 v18, v18, v33
    v_mul_f32 v19, v19, v33
    v_mul_f32 v20, v20, v33
    v_mul_f32 v21, v21, v33
    v_mul_f32 v22, v22, v33
    v_mul_f32 v23, v23, v33
    v_mul_f32 v24, v24, v33
    v_mul_f32 v25, v25, v33
    v_mul_f32 v26, v26, v33
    v_mul_f32 v27, v27, v33
    v_mul_f32 v28, v28, v33
    v_mul_f32 v29, v29, v33
    v_mul_f32 v30, v30, v33
    v_mul_f32 v31, v31, v33
    v_cvt_pk_bf16_f32 v36, v16, v17
    v_cvt_pk_bf16_f32 v37, v18, v19
    v_cvt_pk_bf16_f32 v38, v20, v21
    v_cvt_pk_bf16_f32 v39, v22, v23
    v_cvt_pk_bf16_f32 v40, v24, v25
    v_cvt_pk_bf16_f32 v41, v26, v27
    v_cvt_pk_bf16_f32 v42, v28, v29
    v_cvt_pk_bf16_f32 v43, v30, v31
    v_cmp_gt_u32 vcc, 32, v226
    v_mov_b32 v32, 0
    s_nop 1
    v_cndmask_b32 v42, v32, v42, vcc
    v_cndmask_b32 v43, v32, v43, vcc
    s_sub_u32 s30, s28, 14
    s_lshl_b32 s30, s30, 4
    s_add_u32 s30, s30, 122
    s_lshl_b32 s29, s27, 2
    s_add_u32 s29, s29, s26
    s_mul_i32 s29, s29, 144
    s_add_u32 s29, s29, s30
    s_lshl_b32 s29, s29, 10
    s_add_u32 s29, s29, 1048576
    v_lshlrev_b32 v246, 4, v226
    v_add_u32 v246, s29, v246
    buffer_store_dwordx4 v[36:39], v246, s[44:47], 0 offen sc1
    buffer_store_dwordx4 v[40:43], v246, s[44:47], 0 offen offset:1024 sc1
    s_nop 1
    s_waitcnt vmcnt(0)
    s_barrier
    s_cmp_lg_u32 s24, 0
    s_cbranch_scc1 L_osig_25
    s_add_u32 s29, s27, 32
    s_lshl_b32 s29, s29, 7
    s_add_u32 s29, s29, 86016
    v_mov_b32 v246, s29
    v_mov_b32 v247, 1
    v_cmp_eq_u32 vcc, 0, v226
    s_and_saveexec_b64 s[30:31], vcc
    buffer_atomic_add v247, v246, s[44:47], 0 offen
    s_mov_b64 exec, s[30:31]
L_osig_25:
    s_waitcnt vmcnt(0)
    s_endpgm
L_g1_h1_8:
    s_setprio 1
    ds_read_b128 v[0:3], v216 offset:0
    ds_read_b64_tr_b16 v[192:193], v220 offset:0
    ds_read_b64_tr_b16 v[194:195], v220 offset:512
    ds_read_b64_tr_b16 v[196:197], v221 offset:0
    ds_read_b64_tr_b16 v[198:199], v221 offset:512
    ds_read_b64_tr_b16 v[200:201], v222 offset:0
    ds_read_b64_tr_b16 v[202:203], v222 offset:512
    ds_read_b128 v[4:7], v217 offset:0
    ds_read_b64_tr_b16 v[204:205], v220 offset:2048
    ds_read_b64_tr_b16 v[206:207], v220 offset:2560
    ds_read_b64_tr_b16 v[208:209], v221 offset:2048
    ds_read_b64_tr_b16 v[210:211], v221 offset:2560
    ds_read_b64_tr_b16 v[212:213], v222 offset:2048
    ds_read_b64_tr_b16 v[214:215], v222 offset:2560
    s_waitcnt lgkmcnt(7)
    v_mfma_f32_32x32x16_bf16 v[112:127], v[192:195], v[0:3], 0
    ds_read_b128 v[8:11], v218 offset:0
    ds_read_b64_tr_b16 v[160:161], v220 offset:4096
    ds_read_b64_tr_b16 v[162:163], v220 offset:4608
    s_waitcnt vmcnt(5)
    v_lshlrev_b32 v186, 16, v176
    v_and_b32 v187, s3, v176
    v_lshlrev_b32 v188, 16, v180
    v_and_b32 v189, s3, v180
    v_lshlrev_b32 v246, 16, v177
    v_and_b32 v247, s3, v177
    v_add_f32 v186, v186, v246
    s_add_u32 m0, s61, 32768
    s_nop 0
    buffer_load_dwordx4 v224, s[12:15], s74 offen lds
    s_add_u32 m0, s61, 33792
    v_mfma_f32_32x32x16_bf16 v[128:143], v[196:199], v[0:3], 0
    ds_read_b64_tr_b16 v[164:165], v221 offset:4096
    ds_read_b64_tr_b16 v[166:167], v221 offset:4608
    ds_read_b64_tr_b16 v[168:169], v222 offset:4096
    v_add_f32 v187, v187, v247
    v_lshlrev_b32 v246, 16, v181
    v_and_b32 v247, s3, v181
    v_add_f32 v188, v188, v246
    v_add_f32 v189, v189, v247
    v_lshlrev_b32 v246, 16, v178
    v_and_b32 v247, s3, v178
    v_mfma_f32_32x32x16_bf16 v[144:159], v[200:203], v[0:3], 0
    ds_read_b64_tr_b16 v[170:171], v222 offset:4608
    v_add_f32 v186, v186, v246
    v_add_f32 v187, v187, v247
    v_lshlrev_b32 v246, 16, v182
    v_and_b32 v247, s3, v182
    v_add_f32 v188, v188, v246
    v_add_f32 v189, v189, v247
    v_lshlrev_b32 v246, 16, v179
    buffer_load_dwordx4 v225, s[12:15], s74 offen lds
    s_add_u32 m0, s62, 81920
    s_waitcnt lgkmcnt(7)
    v_mfma_f32_32x32x16_bf16 v[112:127], v[204:207], v[4:7], v[112:127]
    ds_read_b128 v[12:15], v219 offset:0
    ds_read_b64_tr_b16 v[192:193], v220 offset:6144
    ds_read_b64_tr_b16 v[194:195], v220 offset:6656
    v_and_b32 v247, s3, v179
    v_add_f32 v186, v186, v246
    v_add_f32 v187, v187, v247
    v_lshlrev_b32 v246, 16, v183
    v_and_b32 v247, s3, v183
    v_add_f32 v188, v188, v246
    v_add_f32 v189, v189, v247
    buffer_load_dwordx4 v229, s[16:19], s81 offen lds
    s_add_u32 m0, s62, 90112
    v_mfma_f32_32x32x16_bf16 v[128:143], v[208:211], v[4:7], v[128:143]
    ds_read_b64_tr_b16 v[196:197], v221 offset:6144
    ds_read_b64_tr_b16 v[198:199], v221 offset:6656
    ds_read_b64_tr_b16 v[200:201], v222 offset:6144
    v_lshlrev_b32 v190, 16, v184
    v_and_b32 v191, s3, v184
    v_lshlrev_b32 v246, 16, v185
    v_and_b32 v247, s3, v185
    v_add_f32 v190, v190, v246
    v_add_f32 v191, v191, v247
    v_mov_b32 v246, v190
    v_mfma_f32_32x32x16_bf16 v[144:159], v[212:215], v[4:7], v[144:159]
    ds_read_b64_tr_b16 v[202:203], v222 offset:6656
    v_mov_b32 v247, v191
    s_mul_i32 s29, s24, 1280
    s_add_u32 s29, s29, 122880
    v_permlane32_swap_b32 v190, v246
    v_permlane32_swap_b32 v191, v247
    v_lshlrev_b32 v248, 3, v226
    v_add_u32 v248, s29, v248
    v_add_f32 v190, v190, v246
    v_add_f32 v191, v191, v247
    buffer_load_dwordx4 v230, s[20:23], s81 offen lds
    s_add_u32 m0, s62, 114688
    s_waitcnt lgkmcnt(7)
    v_mfma_f32_32x32x16_bf16 v[112:127], v[160:163], v[8:11], v[112:127]
    v_and_b32 v249, 31, v226
    v_lshlrev_b32 v249, 3, v249
    v_add_u32 v249, s29, v249
    ds_write_b64 v248, v[186:187]
    ds_write_b64 v248, v[188:189] offset:512
    ds_write_b64 v249, v[190:191] offset:1024
    buffer_load_dword v251, v241, s[52:55], 0 offen sc1
    v_mfma_f32_32x32x16_bf16 v[128:143], v[164:167], v[8:11], v[128:143]
    buffer_load_dwordx4 v223, s[48:51], s88 offen lds
    s_waitcnt lgkmcnt(0)
    s_waitcnt vmcnt(6)
    s_barrier
    ds_read_b128 v[16:19], v216 offset:16384
    ds_read_b64_tr_b16 v[204:205], v220 offset:16384
    ds_read_b64_tr_b16 v[206:207], v220 offset:16896
    ds_read_b64_tr_b16 v[208:209], v221 offset:16384
    ds_read_b32 v176, v238 offset:0
    ds_read_b32 v177, v238 offset:1280
    ds_read_b32 v178, v238 offset:2560
    ds_read_b32 v179, v238 offset:3840
    ds_read_b32 v180, v238 offset:5120
    ds_read_b32 v181, v238 offset:6400
    v_mfma_f32_32x32x16_bf16 v[144:159], v[168:171], v[8:11], v[144:159]
    ds_read_b64_tr_b16 v[210:211], v221 offset:16896
    ds_read_b64_tr_b16 v[212:213], v222 offset:16384
    ds_read_b64_tr_b16 v[214:215], v222 offset:16896
    ds_read_b32 v182, v238 offset:7680
    ds_read_b32 v183, v238 offset:8960
    v_lshlrev_b32 v246, 16, v172
    v_and_b32 v247, s3, v172
    v_add_f32 v184, v246, v247
    v_mul_f32 v185, v246, v246
    v_mfma_f32_32x32x16_bf16 v[112:127], v[192:195], v[12:15], v[112:127]
    ds_read_b128 v[20:23], v217 offset:16384
    ds_read_b64_tr_b16 v[160:161], v220 offset:18432
    ds_read_b64_tr_b16 v[162:163], v220 offset:18944
    v_fmac_f32 v185, v247, v247
    v_lshlrev_b32 v246, 16, v173
    v_and_b32 v247, s3, v173
    v_add_f32 v184, v184, v246
    v_fmac_f32 v185, v246, v246
    v_add_f32 v184, v184, v247
    s_add_u32 m0, s61, 0
    s_nop 0
    buffer_load_dwordx4 v224, s[12:15], s75 offen lds
    s_add_u32 m0, s61, 1024
    v_mfma_f32_32x32x16_bf16 v[128:143], v[196:199], v[12:15], v[128:143]
    ds_read_b64_tr_b16 v[164:165], v221 offset:18432
    ds_read_b64_tr_b16 v[166:167], v221 offset:18944
    ds_read_b64_tr_b16 v[168:169], v222 offset:18432
    v_fmac_f32 v185, v247, v247
    v_lshlrev_b32 v246, 16, v174
    v_and_b32 v247, s3, v174
    v_add_f32 v184, v184, v246
    v_fmac_f32 v185, v246, v246
    v_add_f32 v184, v184, v247
    v_mfma_f32_32x32x16_bf16 v[144:159], v[200:203], v[12:15], v[144:159]
    ds_read_b64_tr_b16 v[170:171], v222 offset:18944
    v_fmac_f32 v185, v247, v247
    v_lshlrev_b32 v246, 16, v175
    v_and_b32 v247, s3, v175
    v_add_f32 v184, v184, v246
    v_fmac_f32 v185, v246, v246
    v_add_f32 v184, v184, v247
    buffer_load_dwordx4 v225, s[12:15], s75 offen lds
    s_add_u32 m0, s62, 49152
    s_waitcnt lgkmcnt(9)
    v_mfma_f32_32x32x16_bf16 v[112:127], v[204:207], v[16:19], v[112:127]
    ds_read_b128 v[24:27], v218 offset:16384
    ds_read_b64_tr_b16 v[192:193], v220 offset:20480
    ds_read_b64_tr_b16 v[194:195], v220 offset:20992
    v_fmac_f32 v185, v247, v247
    s_nop 0
    v_add_f32_dpp v184, v184, v184 row_shr:1 row_mask:0xf bank_mask:0xf bound_ctrl:0
    v_add_f32_dpp v185, v185, v185 row_shr:1 row_mask:0xf bank_mask:0xf bound_ctrl:0
    s_nop 0
    v_add_f32_dpp v184, v184, v184 row_shr:2 row_mask:0xf bank_mask:0xf bound_ctrl:0
    v_add_f32_dpp v185, v185, v185 row_shr:2 row_mask:0xf bank_mask:0xf bound_ctrl:0
    s_nop 0
    v_add_f32_dpp v184, v184, v184 row_shr:4 row_mask:0xf bank_mask:0xf bound_ctrl:0
    buffer_load_dwordx4 v229, s[16:19], s82 offen lds
    s_add_u32 m0, s62, 57344
    v_mfma_f32_32x32x16_bf16 v[128:143], v[208:211], v[16:19], v[128:143]
    ds_read_b64_tr_b16 v[196:197], v221 offset:20480
    ds_read_b64_tr_b16 v[198:199], v221 offset:20992
    ds_read_b64_tr_b16 v[200:201], v222 offset:20480
    v_add_f32_dpp v185, v185, v185 row_shr:4 row_mask:0xf bank_mask:0xf bound_ctrl:0
    s_nop 0
    v_add_f32_dpp v184, v184, v184 row_shr:8 row_mask:0xf bank_mask:0xf bound_ctrl:0
    v_add_f32_dpp v185, v185, v185 row_shr:8 row_mask:0xf bank_mask:0xf bound_ctrl:0
    s_nop 0
    v_add_f32_dpp v184, v184, v184 row_bcast:15 row_mask:0xa bank_mask:0xf
    v_add_f32_dpp v185, v185, v185 row_bcast:15 row_mask:0xa bank_mask:0xf
    s_nop 0
    v_add_f32_dpp v184, v184, v184 row_bcast:31 row_mask:0xc bank_mask:0xf
    v_mfma_f32_32x32x16_bf16 v[144:159], v[212:215], v[16:19], v[144:159]
    ds_read_b64_tr_b16 v[202:203], v222 offset:20992
    v_add_f32_dpp v185, v185, v185 row_bcast:31 row_mask:0xc bank_mask:0xf
    s_nop 0
    v_readlane_b32 s29, v184, 63
    v_readlane_b32 s30, v185, 63
    v_mov_b32 v250, 991054117
    s_nop 0
    v_mul_f32 v184, s29, v250
    v_mul_f32 v185, s30, v250
    buffer_load_dwordx4 v230, s[20:23], s82 offen lds
    s_add_u32 m0, s62, 98304
    s_waitcnt lgkmcnt(7)
    v_mfma_f32_32x32x16_bf16 v[112:127], v[160:163], v[20:23], v[112:127]
    ds_read_b128 v[28:31], v219 offset:16384
    ds_read_b64_tr_b16 v[204:205], v220 offset:22528
    ds_read_b64_tr_b16 v[206:207], v220 offset:23040
    v_fma_f32 v185, -v184, v184, v185
    v_max_f32 v185, 0, v185
    v_cvt_pk_bf16_f32 v246, v185, v184
    v_lshlrev_b32 v247, 16, v246
    v_add_f32 v247, 925353388, v247
    v_cvt_pk_bf16_f32 v247, v247, v247
    buffer_load_dwordx4 v223, s[48:51], s89 offen lds
    v_mfma_f32_32x32x16_bf16 v[128:143], v[164:167], v[20:23], v[128:143]
    ds_read_b64_tr_b16 v[208:209], v221 offset:22528
    ds_read_b64_tr_b16 v[210:211], v221 offset:23040
    ds_read_b64_tr_b16 v[212:213], v222 offset:22528
    v_lshlrev_b32 v247, 16, v247
    v_sqrt_f32 v247, v247
    v_lshrrev_b32 v173, 16, v246
    v_cvt_pk_bf16_f32 v247, v247, v247
    v_lshlrev_b32 v172, 16, v247
    v_mfma_f32_32x32x16_bf16 v[144:159], v[168:171], v[20:23], v[144:159]
    ds_read_b64_tr_b16 v[214:215], v222 offset:23040
    v_add_f32 v176, v176, v177
    v_add_f32 v176, v176, v178
    v_add_f32 v176, v176, v179
    v_add_f32 v176, v176, v180
    v_add_f32 v176, v176, v181
    v_add_f32 v176, v176, v182
    s_waitcnt lgkmcnt(7)
    v_mfma_f32_32x32x16_bf16 v[112:127], v[192:195], v[24:27], v[112:127]
    v_add_f32 v176, v176, v183
    v_mfma_f32_32x32x16_bf16 v[128:143], v[196:199], v[24:27], v[128:143]
    s_waitcnt vmcnt(6)
    v_cmp_gt_u32 vcc, 8, v251
    s_nop 4
    s_cbranch_vccnz L_go_slow_28
L_go_back_29:
    buffer_atomic_add_f32 v176, v239, s[44:47], 0 offen
    buffer_store_dwordx2 v[172:173], v240, s[44:47], 0 offen sc1
    s_waitcnt lgkmcnt(0)
    s_waitcnt vmcnt(7)
    s_barrier
    ds_read_b128 v[32:35], v216 offset:32768
    ds_read_b64_tr_b16 v[160:161], v220 offset:32768
    ds_read_b64_tr_b16 v[162:163], v220 offset:33280
    ds_read_b64_tr_b16 v[164:165], v221 offset:32768
    v_mfma_f32_32x32x16_bf16 v[144:159], v[200:203], v[24:27], v[144:159]
    ds_read_b64_tr_b16 v[166:167], v221 offset:33280
    ds_read_b64_tr_b16 v[168:169], v222 offset:32768
    ds_read_b64_tr_b16 v[170:171], v222 offset:33280
    v_mfma_f32_32x32x16_bf16 v[112:127], v[204:207], v[28:31], v[112:127]
    ds_read_b128 v[36:39], v217 offset:32768
    ds_read_b64_tr_b16 v[192:193], v220 offset:34816
    ds_read_b64_tr_b16 v[194:195], v220 offset:35328
    s_add_u32 m0, s61, 16384
    s_nop 0
    buffer_load_dwordx4 v224, s[12:15], s76 offen lds
    s_add_u32 m0, s61, 17408
    v_mfma_f32_32x32x16_bf16 v[128:143], v[208:211], v[28:31], v[128:143]
    ds_read_b64_tr_b16 v[196:197], v221 offset:34816
    ds_read_b64_tr_b16 v[198:199], v221 offset:35328
    ds_read_b64_tr_b16 v[200:201], v222 offset:34816
    v_mfma_f32_32x32x16_bf16 v[144:159], v[212:215], v[28:31], v[144:159]
    ds_read_b64_tr_b16 v[202:203], v222 offset:35328
    buffer_load_dwordx4 v225, s[12:15], s76 offen lds
    s_add_u32 m0, s62, 65536
    s_waitcnt lgkmcnt(7)
    v_mfma_f32_32x32x16_bf16 v[112:127], v[160:163], v[32:35], v[112:127]
    ds_read_b128 v[40:43], v218 offset:32768
    ds_read_b64_tr_b16 v[204:205], v220 offset:36864
    ds_read_b64_tr_b16 v[206:207], v220 offset:37376
    buffer_load_dwordx4 v229, s[16:19], s83 offen lds
    s_add_u32 m0, s62, 73728
    v_mfma_f32_32x32x16_bf16 v[128:143], v[164:167], v[32:35], v[128:143]
    ds_read_b64_tr_b16 v[208:209], v221 offset:36864
    ds_read_b64_tr_b16 v[210:211], v221 offset:37376
    ds_read_b64_tr_b16 v[212:213], v222 offset:36864
    v_mfma_f32_32x32x16_bf16 v[144:159], v[168:171], v[32:35], v[144:159]
    ds_read_b64_tr_b16 v[214:215], v222 offset:37376
    buffer_load_dwordx4 v230, s[20:23], s83 offen lds
    s_add_u32 m0, s62, 106496
    s_waitcnt lgkmcnt(7)
    v_mfma_f32_32x32x16_bf16 v[112:127], v[192:195], v[36:39], v[112:127]
    ds_read_b128 v[44:47], v219 offset:32768
    ds_read_b64_tr_b16 v[160:161], v220 offset:38912
    ds_read_b64_tr_b16 v[162:163], v220 offset:39424
    buffer_load_dwordx4 v223, s[48:51], s90 offen lds
    v_mfma_f32_32x32x16_bf16 v[128:143], v[196:199], v[36:39], v[128:143]
    ds_read_b64_tr_b16 v[164:165], v221 offset:38912
    ds_read_b64_tr_b16 v[166:167], v221 offset:39424
    ds_read_b64_tr_b16 v[168:169], v222 offset:38912
    v_mfma_f32_32x32x16_bf16 v[144:159], v[200:203], v[36:39], v[144:159]
    ds_read_b64_tr_b16 v[170:171], v222 offset:39424
    s_waitcnt lgkmcnt(7)
    v_mfma_f32_32x32x16_bf16 v[112:127], v[204:207], v[40:43], v[112:127]
    v_mfma_f32_32x32x16_bf16 v[128:143], v[208:211], v[40:43], v[128:143]
    s_waitcnt vmcnt(5)
    s_waitcnt lgkmcnt(0)
    s_barrier
    ds_read_b128 v[48:51], v216 offset:0
    ds_read_b64_tr_b16 v[192:193], v220 offset:0
    ds_read_b64_tr_b16 v[194:195], v220 offset:512
    ds_read_b64_tr_b16 v[196:197], v221 offset:0
    v_mfma_f32_32x32x16_bf16 v[144:159], v[212:215], v[40:43], v[144:159]
    ds_read_b64_tr_b16 v[198:199], v221 offset:512
    ds_read_b64_tr_b16 v[200:201], v222 offset:0
    ds_read_b64_tr_b16 v[202:203], v222 offset:512
    s_cmp_lg_u32 s24, 0
    s_cbranch_scc1 L_presig_30
    s_add_u32 s29, s27, 48
    s_lshl_b32 s29, s29, 7
    s_add_u32 s29, s29, 86016
    v_mov_b32 v246, s29
    v_mov_b32 v247, 1
    v_cmp_eq_u32 vcc, 0, v226
    s_and_saveexec_b64 s[30:31], vcc
    buffer_atomic_add v247, v246, s[44:47], 0 offen
    s_mov_b64 exec, s[30:31]
    s_add_u32 s29, s28, 64
    s_lshl_b32 s29, s29, 7
    s_add_u32 s29, s29, 86016
    v_mov_b32 v246, s29
    v_mov_b32 v247, 1
    v_cmp_eq_u32 vcc, 0, v226
    s_and_saveexec_b64 s[30:31], vcc
    buffer_atomic_add v247, v246, s[44:47], 0 offen
    s_mov_b64 exec, s[30:31]
L_presig_30:
    v_mfma_f32_32x32x16_bf16 v[112:127], v[160:163], v[44:47], v[112:127]
    ds_read_b128 v[52:55], v217 offset:0
    ds_read_b64_tr_b16 v[204:205], v220 offset:2048
    ds_read_b64_tr_b16 v[206:207], v220 offset:2560
    s_add_u32 m0, s61, 32768
    s_nop 0
    buffer_load_dwordx4 v224, s[12:15], s77 offen lds
    s_add_u32 m0, s61, 33792
    v_mfma_f32_32x32x16_bf16 v[128:143], v[164:167], v[44:47], v[128:143]
    ds_read_b64_tr_b16 v[208:209], v221 offset:2048
    ds_read_b64_tr_b16 v[210:211], v221 offset:2560
    ds_read_b64_tr_b16 v[212:213], v222 offset:2048
    v_mfma_f32_32x32x16_bf16 v[144:159], v[168:171], v[44:47], v[144:159]
    ds_read_b64_tr_b16 v[214:215], v222 offset:2560
    buffer_load_dwordx4 v225, s[12:15], s77 offen lds
    s_add_u32 m0, s62, 81920
    s_waitcnt lgkmcnt(7)
    v_mfma_f32_32x32x16_bf16 v[112:127], v[192:195], v[48:51], v[112:127]
    ds_read_b128 v[56:59], v218 offset:0
    ds_read_b64_tr_b16 v[160:161], v220 offset:4096
    ds_read_b64_tr_b16 v[162:163], v220 offset:4608
    buffer_load_dwordx4 v229, s[16:19], s84 offen lds
    s_add_u32 m0, s62, 90112
    v_mfma_f32_32x32x16_bf16 v[128:143], v[196:199], v[48:51], v[128:143]
    ds_read_b64_tr_b16 v[164:165], v221 offset:4096
    ds_read_b64_tr_b16 v[166:167], v221 offset:4608
    ds_read_b64_tr_b16 v[168:169], v222 offset:4096
    v_mfma_f32_32x32x16_bf16 v[144:159], v[200:203], v[48:51], v[144:159]
    ds_read_b64_tr_b16 v[170:171], v222 offset:4608
    buffer_load_dwordx4 v230, s[20:23], s84 offen lds
    s_add_u32 m0, s62, 114688
    s_waitcnt lgkmcnt(7)
    v_mfma_f32_32x32x16_bf16 v[112:127], v[204:207], v[52:55], v[112:127]
    ds_read_b128 v[60:63], v219 offset:0
    ds_read_b64_tr_b16 v[192:193], v220 offset:6144
    ds_read_b64_tr_b16 v[194:195], v220 offset:6656
    buffer_load_dwordx4 v223, s[48:51], s91 offen lds
    v_mfma_f32_32x32x16_bf16 v[128:143], v[208:211], v[52:55], v[128:143]
    ds_read_b64_tr_b16 v[196:197], v221 offset:6144
    ds_read_b64_tr_b16 v[198:199], v221 offset:6656
    ds_read_b64_tr_b16 v[200:201], v222 offset:6144
    v_mfma_f32_32x32x16_bf16 v[144:159], v[212:215], v[52:55], v[144:159]
    ds_read_b64_tr_b16 v[202:203], v222 offset:6656
    s_waitcnt lgkmcnt(7)
    v_mfma_f32_32x32x16_bf16 v[112:127], v[160:163], v[56:59], v[112:127]
    v_mfma_f32_32x32x16_bf16 v[128:143], v[164:167], v[56:59], v[128:143]
    s_waitcnt lgkmcnt(0)
    s_waitcnt vmcnt(5)
    s_barrier
    ds_read_b128 v[64:67], v216 offset:16384
    ds_read_b64_tr_b16 v[204:205], v220 offset:16384
    ds_read_b64_tr_b16 v[206:207], v220 offset:16896
    ds_read_b64_tr_b16 v[208:209], v221 offset:16384
    v_mfma_f32_32x32x16_bf16 v[144:159], v[168:171], v[56:59], v[144:159]
    ds_read_b64_tr_b16 v[210:211], v221 offset:16896
    ds_read_b64_tr_b16 v[212:213], v222 offset:16384
    ds_read_b64_tr_b16 v[214:215], v222 offset:16896
    v_mfma_f32_32x32x16_bf16 v[112:127], v[192:195], v[60:63], v[112:127]
    ds_read_b128 v[68:71], v217 offset:16384
    ds_read_b64_tr_b16 v[160:161], v220 offset:18432
    ds_read_b64_tr_b16 v[162:163], v220 offset:18944
    s_add_u32 m0, s61, 0
    s_nop 0
    buffer_load_dwordx4 v224, s[12:15], s78 offen lds
    s_add_u32 m0, s61, 1024
    v_mfma_f32_32x32x16_bf16 v[128:143], v[196:199], v[60:63], v[128:143]
    ds_read_b64_tr_b16 v[164:165], v221 offset:18432
    ds_read_b64_tr_b16 v[166:167], v221 offset:18944
    ds_read_b64_tr_b16 v[168:169], v222 offset:18432
    v_mfma_f32_32x32x16_bf16 v[144:159], v[200:203], v[60:63], v[144:159]
    ds_read_b64_tr_b16 v[170:171], v222 offset:18944
    buffer_load_dwordx4 v225, s[12:15], s78 offen lds
    s_add_u32 m0, s62, 49152
    s_waitcnt lgkmcnt(7)
    v_mfma_f32_32x32x16_bf16 v[112:127], v[204:207], v[64:67], v[112:127]
    ds_read_b128 v[72:75], v218 offset:16384
    ds_read_b64_tr_b16 v[192:193], v220 offset:20480
    ds_read_b64_tr_b16 v[194:195], v220 offset:20992
    buffer_load_dwordx4 v229, s[16:19], s85 offen lds
    s_add_u32 m0, s62, 57344
    v_mfma_f32_32x32x16_bf16 v[128:143], v[208:211], v[64:67], v[128:143]
    ds_read_b64_tr_b16 v[196:197], v221 offset:20480
    ds_read_b64_tr_b16 v[198:199], v221 offset:20992
    ds_read_b64_tr_b16 v[200:201], v222 offset:20480
    v_mfma_f32_32x32x16_bf16 v[144:159], v[212:215], v[64:67], v[144:159]
    ds_read_b64_tr_b16 v[202:203], v222 offset:20992
    buffer_load_dwordx4 v230, s[20:23], s85 offen lds
    s_add_u32 m0, s62, 98304
    s_waitcnt lgkmcnt(7)
    v_mfma_f32_32x32x16_bf16 v[112:127], v[160:163], v[68:71], v[112:127]
    ds_read_b128 v[76:79], v219 offset:16384
    ds_read_b64_tr_b16 v[204:205], v220 offset:22528
    ds_read_b64_tr_b16 v[206:207], v220 offset:23040
    buffer_load_dwordx4 v223, s[48:51], s92 offen lds
    v_mfma_f32_32x32x16_bf16 v[128:143], v[164:167], v[68:71], v[128:143]
    ds_read_b64_tr_b16 v[208:209], v221 offset:22528
    ds_read_b64_tr_b16 v[210:211], v221 offset:23040
    ds_read_b64_tr_b16 v[212:213], v222 offset:22528
    v_mfma_f32_32x32x16_bf16 v[144:159], v[168:171], v[68:71], v[144:159]
    ds_read_b64_tr_b16 v[214:215], v222 offset:23040
    s_waitcnt lgkmcnt(7)
    v_mfma_f32_32x32x16_bf16 v[112:127], v[192:195], v[72:75], v[112:127]
    v_mfma_f32_32x32x16_bf16 v[128:143], v[196:199], v[72:75], v[128:143]
    s_waitcnt lgkmcnt(0)
    s_waitcnt vmcnt(5)
    s_barrier
    ds_read_b128 v[80:83], v216 offset:32768
    ds_read_b64_tr_b16 v[160:161], v220 offset:32768
    ds_read_b64_tr_b16 v[162:163], v220 offset:33280
    ds_read_b64_tr_b16 v[164:165], v221 offset:32768
    v_mfma_f32_32x32x16_bf16 v[144:159], v[200:203], v[72:75], v[144:159]
    ds_read_b64_tr_b16 v[166:167], v221 offset:33280
    ds_read_b64_tr_b16 v[168:169], v222 offset:32768
    ds_read_b64_tr_b16 v[170:171], v222 offset:33280
    s_mov_b32 s40, s64
    s_and_b32 s41, s65, 0xffff
    s_mov_b32 s42, 1605632
    s_mov_b32 s43, 0x20000
    s_and_b32 s10, s70, 3
    s_mul_i32 s10, s10, 448
    s_lshl_b32 s11, s24, 3
    s_add_u32 s10, s10, s11
    s_mul_i32 s10, s10, 896
    s_lshl_b32 s11, s71, 7
    s_add_u32 s10, s10, s11
    s_lshl_b32 s11, s34, 30
    s_add_u32 s60, s10, s11
    v_mul_u32_u24 v225, 896, v226
    v_cmp_gt_u32 vcc, 8, v226
    v_mov_b32 v237, 0x40000000
    s_nop 0
    v_cndmask_b32 v225, v237, v225, vcc
    s_add_u32 s29, s27, 48
    s_add_u32 s30, s28, 64
    v_and_b32 v253, 1, v226
    v_cmp_eq_u32 vcc, 0, v253
    v_mov_b32 v253, s30
    v_mov_b32 v254, s29
    v_cndmask_b32 v253, v253, v254, vcc
    v_lshlrev_b32 v253, 7, v253
    v_add_u32 v253, 86016, v253
    s_cmp_eq_u32 s24, 0
    s_cselect_b32 s29, 0, 0x40000000
    buffer_load_dword v254, v253, s[44:47], s29 offen sc1
    v_mfma_f32_32x32x16_bf16 v[112:127], v[204:207], v[76:79], v[112:127]
    ds_read_b128 v[84:87], v217 offset:32768
    ds_read_b64_tr_b16 v[192:193], v220 offset:34816
    ds_read_b64_tr_b16 v[194:195], v220 offset:35328
    v_add_u32 v229, s39, v229
    v_add_u32 v230, s39, v230
    s_add_u32 m0, s62, 65536
    s_nop 0
    buffer_load_dwordx4 v229, s[16:19], s79 offen lds
    s_add_u32 m0, s62, 73728
    v_mfma_f32_32x32x16_bf16 v[128:143], v[208:211], v[76:79], v[128:143]
    ds_read_b64_tr_b16 v[196:197], v221 offset:34816
    ds_read_b64_tr_b16 v[198:199], v221 offset:35328
    ds_read_b64_tr_b16 v[200:201], v222 offset:34816
    v_mfma_f32_32x32x16_bf16 v[144:159], v[212:215], v[76:79], v[144:159]
    ds_read_b64_tr_b16 v[202:203], v222 offset:35328
    buffer_load_dwordx4 v230, s[20:23], s79 offen lds
    s_waitcnt lgkmcnt(7)
    v_mfma_f32_32x32x16_bf16 v[112:127], v[160:163], v[80:83], v[112:127]
    ds_read_b128 v[88:91], v218 offset:32768
    ds_read_b64_tr_b16 v[204:205], v220 offset:36864
    ds_read_b64_tr_b16 v[206:207], v220 offset:37376
    v_mfma_f32_32x32x16_bf16 v[128:143], v[164:167], v[80:83], v[128:143]
    ds_read_b64_tr_b16 v[208:209], v221 offset:36864
    ds_read_b64_tr_b16 v[210:211], v221 offset:37376
    ds_read_b64_tr_b16 v[212:213], v222 offset:36864
    v_mfma_f32_32x32x16_bf16 v[144:159], v[168:171], v[80:83], v[144:159]
    ds_read_b64_tr_b16 v[214:215], v222 offset:37376
    s_waitcnt lgkmcnt(7)
    v_mfma_f32_32x32x16_bf16 v[112:127], v[192:195], v[84:87], v[112:127]
    ds_read_b128 v[92:95], v219 offset:32768
    ds_read_b64_tr_b16 v[160:161], v220 offset:38912
    ds_read_b64_tr_b16 v[162:163], v220 offset:39424
    v_mfma_f32_32x32x16_bf16 v[128:143], v[196:199], v[84:87], v[128:143]
    ds_read_b64_tr_b16 v[164:165], v221 offset:38912
    ds_read_b64_tr_b16 v[166:167], v221 offset:39424
    ds_read_b64_tr_b16 v[168:169], v222 offset:38912
    v_mfma_f32_32x32x16_bf16 v[144:159], v[200:203], v[84:87], v[144:159]
    ds_read_b64_tr_b16 v[170:171], v222 offset:39424
    s_waitcnt lgkmcnt(7)
    v_mfma_f32_32x32x16_bf16 v[112:127], v[204:207], v[88:91], v[112:127]
    v_mfma_f32_32x32x16_bf16 v[128:143], v[208:211], v[88:91], v[128:143]
    s_waitcnt vmcnt(2)
    s_cmp_lg_u32 s24, 0
    s_cbranch_scc1 L_prew_31
    v_cmp_gt_u32 vcc, 16, v254
    s_nop 4
    s_cbranch_vccnz L_prew_slow_32
L_prew_back_33:
L_prew_31:
    s_waitcnt lgkmcnt(0)
    s_barrier
    ds_read_b128 v[96:99], v216 offset:0
    ds_read_b64_tr_b16 v[192:193], v220 offset:0
    ds_read_b64_tr_b16 v[194:195], v220 offset:512
    ds_read_b64_tr_b16 v[196:197], v221 offset:0
    v_mfma_f32_32x32x16_bf16 v[144:159], v[212:215], v[88:91], v[144:159]
    ds_read_b64_tr_b16 v[198:199], v221 offset:512
    ds_read_b64_tr_b16 v[200:201], v222 offset:0
    ds_read_b64_tr_b16 v[202:203], v222 offset:512
    s_cmp_eq_u32 s34, 1
    s_cbranch_scc1 L_g1_scA_26
    s_mov_b32 s90, -1
    s_mov_b32 s91, 0
    s_lshl_b32 s29, s27, 7
    s_lshl_b32 s30, s26, 5
    s_add_u32 s29, s29, s30
    v_and_b32 v246, 31, v226
    v_add_u32 v246, s29, v246
    v_lshlrev_b32 v246, 3, v246
    v_add_u32 v246, 131072, v246
    buffer_load_dwordx2 v[234:235], v246, s[44:47], 0 offen sc1
    s_mul_i32 s29, s28, 1280
    s_mov_b32 s31, 1
    s_lshl_b32 s31, s31, 6
    s_add_u32 s29, s29, s31
    s_add_u32 s29, s29, 65536
    v_and_b32 v247, 15, v226
    v_lshl_add_u32 v247, v247, 2, s29
    v_bfe_u32 v253, v226, 4, 1
    v_lshl_add_u32 v247, v253, 9, v247
    buffer_load_dword v231, v247, s[44:47], 0 offen sc1
    s_mul_i32 s29, s28, 1280
    s_mov_b32 s31, 2
    s_lshl_b32 s31, s31, 6
    s_add_u32 s29, s29, s31
    s_add_u32 s29, s29, 65536
    v_and_b32 v247, 15, v226
    v_lshl_add_u32 v247, v247, 2, s29
    v_bfe_u32 v253, v226, 4, 1
    v_lshl_add_u32 v247, v253, 9, v247
    buffer_load_dword v232, v247, s[44:47], 0 offen sc1
    s_mul_i32 s29, s28, 1280
    s_mov_b32 s31, 3
    s_lshl_b32 s31, s31, 6
    s_add_u32 s29, s29, s31
    s_add_u32 s29, s29, 65536
    v_and_b32 v247, 15, v226
    v_lshl_add_u32 v247, v247, 2, s29
    v_bfe_u32 v253, v226, 4, 1
    v_lshl_add_u32 v247, v253, 9, v247
    buffer_load_dword v233, v247, s[44:47], 0 offen sc1
    s_branch L_g1_scD_27
L_g1_scA_26:
    s_mov_b32 s90, -1
    s_mov_b32 s91, 0
    s_lshl_b32 s29, s27, 7
    s_lshl_b32 s30, s26, 5
    s_add_u32 s29, s29, s30
    v_and_b32 v246, 31, v226
    v_add_u32 v246, s29, v246
    v_lshlrev_b32 v246, 3, v246
    v_add_u32 v246, 131072, v246
    buffer_load_dwordx2 v[234:235], v246, s[44:47], 0 offen sc1
    s_mul_i32 s29, s28, 1280
    s_mov_b32 s31, 1
    s_mul_i32 s31, s31, 112
    s_add_u32 s29, s29, s31
    s_add_u32 s29, s29, 65536
    v_and_b32 v247, 31, v226
    v_lshl_add_u32 v247, v247, 2, s29
    buffer_load_dword v231, v247, s[44:47], 0 offen sc1
    s_mul_i32 s29, s28, 1280
    s_mov_b32 s31, 2
    s_mul_i32 s31, s31, 112
    s_add_u32 s29, s29, s31
    s_add_u32 s29, s29, 65536
    v_and_b32 v247, 31, v226
    v_lshl_add_u32 v247, v247, 2, s29
    buffer_load_dword v232, v247, s[44:47], 0 offen sc1
    s_mul_i32 s29, s28, 1280
    s_mov_b32 s31, 3
    s_mul_i32 s31, s31, 112
    s_add_u32 s29, s29, s31
    s_add_u32 s29, s29, 65536
    v_and_b32 v247, 31, v226
    v_lshl_add_u32 v247, v247, 2, s29
    buffer_load_dword v233, v247, s[44:47], 0 offen sc1
L_g1_scD_27:
    v_mfma_f32_32x32x16_bf16 v[112:127], v[160:163], v[92:95], v[112:127]
    ds_read_b128 v[100:103], v217 offset:0
    ds_read_b64_tr_b16 v[204:205], v220 offset:2048
    ds_read_b64_tr_b16 v[206:207], v220 offset:2560
    s_add_u32 m0, s62, 81920
    s_nop 0
    buffer_load_dwordx4 v229, s[16:19], s80 offen lds
    s_add_u32 m0, s62, 90112
    v_mfma_f32_32x32x16_bf16 v[128:143], v[164:167], v[92:95], v[128:143]
    ds_read_b64_tr_b16 v[208:209], v221 offset:2048
    ds_read_b64_tr_b16 v[210:211], v221 offset:2560
    ds_read_b64_tr_b16 v[212:213], v222 offset:2048
    v_mfma_f32_32x32x16_bf16 v[144:159], v[168:171], v[92:95], v[144:159]
    ds_read_b64_tr_b16 v[214:215], v222 offset:2560
    buffer_load_dwordx4 v230, s[20:23], s80 offen lds
    s_waitcnt lgkmcnt(7)
    v_mfma_f32_32x32x16_bf16 v[112:127], v[192:195], v[96:99], v[112:127]
    ds_read_b128 v[104:107], v218 offset:0
    ds_read_b64_tr_b16 v[160:161], v220 offset:4096
    ds_read_b64_tr_b16 v[162:163], v220 offset:4608
    buffer_load_dword v237, v225, s[40:43], s60 offen
    s_add_u32 s60, s60, 57344
    v_mfma_f32_32x32x16_bf16 v[128:143], v[196:199], v[96:99], v[128:143]
    ds_read_b64_tr_b16 v[164:165], v221 offset:4096
    ds_read_b64_tr_b16 v[166:167], v221 offset:4608
    ds_read_b64_tr_b16 v[168:169], v222 offset:4096
    v_mfma_f32_32x32x16_bf16 v[144:159], v[200:203], v[96:99], v[144:159]
    ds_read_b64_tr_b16 v[170:171], v222 offset:4608
    s_waitcnt lgkmcnt(7)
    v_mfma_f32_32x32x16_bf16 v[112:127], v[204:207], v[100:103], v[112:127]
    ds_read_b128 v[108:111], v219 offset:0
    ds_read_b64_tr_b16 v[192:193], v220 offset:6144
    ds_read_b64_tr_b16 v[194:195], v220 offset:6656
    v_mfma_f32_32x32x16_bf16 v[128:143], v[208:211], v[100:103], v[128:143]
    ds_read_b64_tr_b16 v[196:197], v221 offset:6144
    ds_read_b64_tr_b16 v[198:199], v221 offset:6656
    ds_read_b64_tr_b16 v[200:201], v222 offset:6144
    v_mfma_f32_32x32x16_bf16 v[144:159], v[212:215], v[100:103], v[144:159]
    ds_read_b64_tr_b16 v[202:203], v222 offset:6656
    s_waitcnt lgkmcnt(7)
    v_mfma_f32_32x32x16_bf16 v[112:127], v[160:163], v[104:107], v[112:127]
    v_mfma_f32_32x32x16_bf16 v[128:143], v[164:167], v[104:107], v[128:143]
    v_mfma_f32_32x32x16_bf16 v[144:159], v[168:171], v[104:107], v[144:159]
    s_waitcnt lgkmcnt(0)
    v_mfma_f32_32x32x16_bf16 v[112:127], v[192:195], v[108:111], v[112:127]
    v_mfma_f32_32x32x16_bf16 v[128:143], v[196:199], v[108:111], v[128:143]
    v_mfma_f32_32x32x16_bf16 v[144:159], v[200:203], v[108:111], v[144:159]
    s_waitcnt lgkmcnt(0)
    s_waitcnt vmcnt(7)
    s_barrier
    s_add_u32 m0, s62, 49152
    s_nop 0
    buffer_load_dwordx4 v229, s[16:19], s81 offen lds
    s_add_u32 m0, s62, 57344
    s_nop 0
    buffer_load_dwordx4 v230, s[20:23], s81 offen lds
    buffer_load_dword v237, v225, s[40:43], s60 offen
    s_add_u32 s60, s60, 57344
    s_cmp_eq_u32 s34, 1
    s_cbranch_scc1 L_g1_A_34
    ds_read_b64_tr_b16 v[192:193], v227 offset:16384
    ds_read_b64_tr_b16 v[194:195], v227 offset:16896
    ds_read_b64_tr_b16 v[196:197], v228 offset:16384
    ds_read_b64_tr_b16 v[198:199], v228 offset:16896
    ds_read_b64_tr_b16 v[200:201], v227 offset:18432
    ds_read_b64_tr_b16 v[202:203], v227 offset:18944
    ds_read_b64_tr_b16 v[204:205], v228 offset:18432
    ds_read_b64_tr_b16 v[206:207], v228 offset:18944
    s_waitcnt lgkmcnt(4)
    v_mfma_f32_32x32x16_bf16 v[160:175], v[192:195], v[0:3], 0
    s_waitcnt vmcnt(6)
    v_xor_b32 v246, 0x8000, v235
    v_mul_f32 v236, v234, v234
    v_rcp_f32 v234, v234
    v_lshl_or_b32 v238, v246, 16, v246
    v_mfma_f32_32x32x16_bf16 v[176:191], v[196:199], v[0:3], 0
    v_mov_b32 v239, v246
    v_mov_b32 v240, 0
    v_mov_b32 v241, 0
    v_mov_b32 v244, 0
    v_mov_b32 v245, 0
    s_mov_b32 s29, 3216550459
    s_waitcnt lgkmcnt(0)
    v_mfma_f32_32x32x16_bf16 v[160:175], v[200:203], v[4:7], v[160:175]
    ds_read_b64_tr_b16 v[192:193], v227 offset:22528
    ds_read_b64_tr_b16 v[194:195], v227 offset:23040
    v_mul_f32 v235, s29, v234
    s_lshl_b32 s30, s28, 3
    s_lshl_b32 s29, s27, 2
    s_add_u32 s29, s29, s26
    s_mul_i32 s29, s29, 144
    s_add_u32 s29, s29, s30
    s_lshl_b32 s29, s29, 10
    s_add_u32 s29, s29, 1048576
    v_lshlrev_b32 v224, 4, v226
    v_add_u32 v224, s29, v224
    v_cndmask_b32 v231, 0, v231, s[90:91]
    v_and_b32 v246, s3, v231
    v_mfma_f32_32x32x16_bf16 v[176:191], v[204:207], v[4:7], v[176:191]
    ds_read_b64_tr_b16 v[196:197], v228 offset:22528
    ds_read_b64_tr_b16 v[198:199], v228 offset:23040
    v_sub_f32 v231, v231, v246
    v_and_b32 v247, s3, v231
    v_lshrrev_b32 v246, 16, v246
    v_sub_f32 v231, v231, v247
    v_or_b32 v242, v246, v247
    ds_read_b64_tr_b16 v[0:1], v227 offset:20480
    ds_read_b64_tr_b16 v[2:3], v227 offset:20992
    ds_read_b64_tr_b16 v[4:5], v228 offset:20480
    ds_read_b64_tr_b16 v[6:7], v228 offset:20992
    s_waitcnt lgkmcnt(0)
    v_mfma_f32_32x32x16_bf16 v[160:175], v[0:3], v[8:11], v[160:175]
    s_waitcnt lgkmcnt(0)
    s_waitcnt vmcnt(4)
    s_barrier
    ds_read_b64_tr_b16 v[200:201], v227 offset:32768
    ds_read_b64_tr_b16 v[202:203], v227 offset:33280
    v_lshrrev_b32 v243, 16, v231
    s_nop 1
    v_mfma_f32_32x32x16_bf16 v[112:127], v[242:245], v[238:241], v[112:127]
    v_cndmask_b32 v232, 0, v232, s[90:91]
    v_and_b32 v246, s3, v232
    v_mfma_f32_32x32x16_bf16 v[176:191], v[4:7], v[8:11], v[176:191]
    ds_read_b64_tr_b16 v[204:205], v228 offset:32768
    ds_read_b64_tr_b16 v[206:207], v228 offset:33280
    v_sub_f32 v232, v232, v246
    v_and_b32 v247, s3, v232
    v_lshrrev_b32 v246, 16, v246
    v_sub_f32 v232, v232, v247
    v_or_b32 v242, v246, v247
    v_mfma_f32_32x32x16_bf16 v[160:175], v[192:195], v[12:15], v[160:175]
    ds_read_b64_tr_b16 v[0:1], v227 offset:34816
    ds_read_b64_tr_b16 v[2:3], v227 offset:35328
    v_lshrrev_b32 v243, 16, v232
    s_nop 1
    v_mfma_f32_32x32x16_bf16 v[128:143], v[242:245], v[238:241], v[128:143]
    v_cndmask_b32 v233, 0, v233, s[90:91]
    v_and_b32 v246, s3, v233
    s_add_u32 m0, s62, 65536
    s_nop 0
    buffer_load_dwordx4 v229, s[16:19], s82 offen lds
    s_add_u32 m0, s62, 73728
    v_mfma_f32_32x32x16_bf16 v[176:191], v[196:199], v[12:15], v[176:191]
    ds_read_b64_tr_b16 v[4:5], v228 offset:34816
    ds_read_b64_tr_b16 v[6:7], v228 offset:35328
    v_sub_f32 v233, v233, v246
    v_and_b32 v247, s3, v233
    v_lshrrev_b32 v246, 16, v246
    v_sub_f32 v233, v233, v247
    v_or_b32 v242, v246, v247
    buffer_load_dwordx4 v230, s[20:23], s82 offen lds
    s_waitcnt lgkmcnt(4)
    v_mfma_f32_32x32x16_bf16 v[160:175], v[200:203], v[16:19], v[160:175]
    ds_read_b64_tr_b16 v[192:193], v227 offset:36864
    ds_read_b64_tr_b16 v[194:195], v227 offset:37376
    v_lshrrev_b32 v243, 16, v233
    s_nop 1
    v_mfma_f32_32x32x16_bf16 v[144:159], v[242:245], v[238:241], v[144:159]
    v_mul_f32 v208, v112, v235
    v_mul_f32 v209, v113, v235
    buffer_load_dword v237, v225, s[40:43], s60 offen
    s_add_u32 s60, s60, 57344
    v_mfma_f32_32x32x16_bf16 v[176:191], v[204:207], v[16:19], v[176:191]
    ds_read_b64_tr_b16 v[196:197], v228 offset:36864
    ds_read_b64_tr_b16 v[198:199], v228 offset:37376
    v_mul_f32 v210, v114, v235
    v_mul_f32 v211, v115, v235
    v_exp_f32 v208, v208
    v_exp_f32 v209, v209
    buffer_load_dword v237, v225, s[40:43], s60 offen
    s_add_u32 s60, s60, 57344
    s_waitcnt lgkmcnt(4)
    v_mfma_f32_32x32x16_bf16 v[160:175], v[0:3], v[20:23], v[160:175]
    ds_read_b64_tr_b16 v[200:201], v227 offset:38912
    ds_read_b64_tr_b16 v[202:203], v227 offset:39424
    v_exp_f32 v210, v210
    v_exp_f32 v211, v211
    v_mul_f32 v112, v112, v120
    v_mfma_f32_32x32x16_bf16 v[176:191], v[4:7], v[20:23], v[176:191]
    ds_read_b64_tr_b16 v[204:205], v228 offset:38912
    ds_read_b64_tr_b16 v[206:207], v228 offset:39424
    v_mul_f32 v113, v113, v121
    v_mul_f32 v114, v114, v122
    v_mul_f32 v115, v115, v123
    v_fma_f32 v208, v208, v236, v236
    v_fma_f32 v209, v209, v236, v236
    s_waitcnt lgkmcnt(4)
    v_mfma_f32_32x32x16_bf16 v[160:175], v[192:195], v[24:27], v[160:175]
    s_waitcnt lgkmcnt(0)
    s_waitcnt vmcnt(5)
    s_barrier
    ds_read_b64_tr_b16 v[0:1], v227 offset:0
    ds_read_b64_tr_b16 v[2:3], v227 offset:512
    v_fma_f32 v210, v210, v236, v236
    v_fma_f32 v211, v211, v236, v236
    v_rcp_f32 v208, v208
    v_rcp_f32 v209, v209
    v_mfma_f32_32x32x16_bf16 v[176:191], v[196:199], v[24:27], v[176:191]
    ds_read_b64_tr_b16 v[4:5], v228 offset:0
    ds_read_b64_tr_b16 v[6:7], v228 offset:512
    v_rcp_f32 v210, v210
    v_rcp_f32 v211, v211
    v_mul_f32 v112, v112, v208
    v_mfma_f32_32x32x16_bf16 v[160:175], v[200:203], v[28:31], v[160:175]
    ds_read_b64_tr_b16 v[192:193], v227 offset:2048
    ds_read_b64_tr_b16 v[194:195], v227 offset:2560
    v_mul_f32 v113, v113, v209
    v_mul_f32 v114, v114, v210
    v_mul_f32 v115, v115, v211
    v_mul_f32 v208, v116, v235
    v_mul_f32 v209, v117, v235
    s_add_u32 m0, s62, 81920
    s_nop 0
    buffer_load_dwordx4 v229, s[16:19], s83 offen lds
    s_add_u32 m0, s62, 90112
    v_mfma_f32_32x32x16_bf16 v[176:191], v[204:207], v[28:31], v[176:191]
    ds_read_b64_tr_b16 v[196:197], v228 offset:2048
    ds_read_b64_tr_b16 v[198:199], v228 offset:2560
    v_mul_f32 v210, v118, v235
    v_mul_f32 v211, v119, v235
    v_exp_f32 v208, v208
    v_exp_f32 v209, v209
    buffer_load_dwordx4 v230, s[20:23], s83 offen lds
    s_waitcnt lgkmcnt(4)
    v_mfma_f32_32x32x16_bf16 v[160:175], v[0:3], v[32:35], v[160:175]
    ds_read_b64_tr_b16 v[200:201], v227 offset:4096
    ds_read_b64_tr_b16 v[202:203], v227 offset:4608
    v_exp_f32 v210, v210
    v_exp_f32 v211, v211
    v_mul_f32 v116, v116, v124
    buffer_load_dword v237, v225, s[40:43], s60 offen
    s_add_u32 s60, s60, 57344
    v_mfma_f32_32x32x16_bf16 v[176:191], v[4:7], v[32:35], v[176:191]
    ds_read_b64_tr_b16 v[204:205], v228 offset:4096
    ds_read_b64_tr_b16 v[206:207], v228 offset:4608
    v_mul_f32 v117, v117, v125
    v_mul_f32 v118, v118, v126
    v_mul_f32 v119, v119, v127
    v_fma_f32 v208, v208, v236, v236
    v_fma_f32 v209, v209, v236, v236
    buffer_load_dword v237, v225, s[40:43], s60 offen
    s_add_u32 s60, s60, 57344
    s_waitcnt lgkmcnt(4)
    v_mfma_f32_32x32x16_bf16 v[160:175], v[192:195], v[36:39], v[160:175]
    ds_read_b64_tr_b16 v[0:1], v227 offset:6144
    ds_read_b64_tr_b16 v[2:3], v227 offset:6656
    v_fma_f32 v210, v210, v236, v236
    v_fma_f32 v211, v211, v236, v236
    v_rcp_f32 v208, v208
    v_rcp_f32 v209, v209
    v_mfma_f32_32x32x16_bf16 v[176:191], v[196:199], v[36:39], v[176:191]
    ds_read_b64_tr_b16 v[4:5], v228 offset:6144
    ds_read_b64_tr_b16 v[6:7], v228 offset:6656
    v_rcp_f32 v210, v210
    v_rcp_f32 v211, v211
    v_mul_f32 v116, v116, v208
    s_waitcnt lgkmcnt(4)
    v_mfma_f32_32x32x16_bf16 v[160:175], v[200:203], v[40:43], v[160:175]
    s_waitcnt lgkmcnt(0)
    s_waitcnt vmcnt(6)
    s_barrier
    ds_read_b64_tr_b16 v[192:193], v227 offset:16384
    ds_read_b64_tr_b16 v[194:195], v227 offset:16896
    v_mul_f32 v117, v117, v209
    v_mul_f32 v118, v118, v210
    v_mul_f32 v119, v119, v211
    v_cvt_pk_bf16_f32 v216, v112, v113
    v_cvt_pk_bf16_f32 v217, v114, v115
    v_mfma_f32_32x32x16_bf16 v[176:191], v[204:207], v[40:43], v[176:191]
    ds_read_b64_tr_b16 v[196:197], v228 offset:16384
    ds_read_b64_tr_b16 v[198:199], v228 offset:16896
    v_cvt_pk_bf16_f32 v218, v116, v117
    v_cvt_pk_bf16_f32 v219, v118, v119
    buffer_store_dwordx4 v[216:219], v224, s[44:47], 0 offen offset:1024 sc1
    v_mul_f32 v208, v128, v235
    v_mul_f32 v209, v129, v235
    v_mfma_f32_32x32x16_bf16 v[160:175], v[0:3], v[44:47], v[160:175]
    ds_read_b64_tr_b16 v[200:201], v227 offset:18432
    ds_read_b64_tr_b16 v[202:203], v227 offset:18944
    v_mul_f32 v210, v130, v235
    v_mul_f32 v211, v131, v235
    v_exp_f32 v208, v208
    v_exp_f32 v209, v209
    s_add_u32 m0, s62, 49152
    s_nop 0
    buffer_load_dwordx4 v229, s[16:19], s84 offen lds
    s_add_u32 m0, s62, 57344
    v_mfma_f32_32x32x16_bf16 v[176:191], v[4:7], v[44:47], v[176:191]
    ds_read_b64_tr_b16 v[204:205], v228 offset:18432
    ds_read_b64_tr_b16 v[206:207], v228 offset:18944
    v_exp_f32 v210, v210
    v_exp_f32 v211, v211
    v_mul_f32 v128, v128, v136
    buffer_load_dwordx4 v230, s[20:23], s84 offen lds
    s_waitcnt lgkmcnt(4)
    v_mfma_f32_32x32x16_bf16 v[160:175], v[192:195], v[48:51], v[160:175]
    ds_read_b64_tr_b16 v[0:1], v227 offset:20480
    ds_read_b64_tr_b16 v[2:3], v227 offset:20992
    v_mul_f32 v129, v129, v137
    v_mul_f32 v130, v130, v138
    v_mul_f32 v131, v131, v139
    v_fma_f32 v208, v208, v236, v236
    v_fma_f32 v209, v209, v236, v236
    buffer_load_dword v237, v225, s[40:43], s60 offen
    s_add_u32 s60, s60, 57344
    v_mfma_f32_32x32x16_bf16 v[176:191], v[196:199], v[48:51], v[176:191]
    ds_read_b64_tr_b16 v[4:5], v228 offset:20480
    ds_read_b64_tr_b16 v[6:7], v228 offset:20992
    v_fma_f32 v210, v210, v236, v236
    v_fma_f32 v211, v211, v236, v236
    v_rcp_f32 v208, v208
    v_rcp_f32 v209, v209
    s_waitcnt lgkmcnt(4)
    v_mfma_f32_32x32x16_bf16 v[160:175], v[200:203], v[52:55], v[160:175]
    ds_read_b64_tr_b16 v[192:193], v227 offset:22528
    ds_read_b64_tr_b16 v[194:195], v227 offset:23040
    v_rcp_f32 v210, v210
    v_rcp_f32 v211, v211
    v_mul_f32 v128, v128, v208
    v_mfma_f32_32x32x16_bf16 v[176:191], v[204:207], v[52:55], v[176:191]
    ds_read_b64_tr_b16 v[196:197], v228 offset:22528
    ds_read_b64_tr_b16 v[198:199], v228 offset:23040
    v_mul_f32 v129, v129, v209
    v_mul_f32 v130, v130, v210
    v_mul_f32 v131, v131, v211
    v_mul_f32 v208, v132, v235
    v_mul_f32 v209, v133, v235
    s_waitcnt lgkmcnt(4)
    v_mfma_f32_32x32x16_bf16 v[160:175], v[0:3], v[56:59], v[160:175]
    s_waitcnt lgkmcnt(0)
    s_waitcnt vmcnt(6)
    s_barrier
    ds_read_b64_tr_b16 v[200:201], v227 offset:32768
    ds_read_b64_tr_b16 v[202:203], v227 offset:33280
    v_mul_f32 v210, v134, v235
    v_mul_f32 v211, v135, v235
    v_exp_f32 v208, v208
    v_exp_f32 v209, v209
    v_mfma_f32_32x32x16_bf16 v[176:191], v[4:7], v[56:59], v[176:191]
    ds_read_b64_tr_b16 v[204:205], v228 offset:32768
    ds_read_b64_tr_b16 v[206:207], v228 offset:33280
    v_exp_f32 v210, v210
    v_exp_f32 v211, v211
    v_mul_f32 v132, v132, v140
    v_mfma_f32_32x32x16_bf16 v[160:175], v[192:195], v[60:63], v[160:175]
    ds_read_b64_tr_b16 v[0:1], v227 offset:34816
    ds_read_b64_tr_b16 v[2:3], v227 offset:35328
    v_mul_f32 v133, v133, v141
    v_mul_f32 v134, v134, v142
    v_mul_f32 v135, v135, v143
    v_fma_f32 v208, v208, v236, v236
    v_fma_f32 v209, v209, v236, v236
    s_add_u32 m0, s62, 65536
    s_nop 0
    buffer_load_dwordx4 v229, s[16:19], s85 offen lds
    s_add_u32 m0, s62, 73728
    v_mfma_f32_32x32x16_bf16 v[176:191], v[196:199], v[60:63], v[176:191]
    ds_read_b64_tr_b16 v[4:5], v228 offset:34816
    ds_read_b64_tr_b16 v[6:7], v228 offset:35328
    v_fma_f32 v210, v210, v236, v236
    v_fma_f32 v211, v211, v236, v236
    v_rcp_f32 v208, v208
    v_rcp_f32 v209, v209
    buffer_load_dwordx4 v230, s[20:23], s85 offen lds
    s_waitcnt lgkmcnt(4)
    v_mfma_f32_32x32x16_bf16 v[160:175], v[200:203], v[64:67], v[160:175]
    ds_read_b64_tr_b16 v[192:193], v227 offset:36864
    ds_read_b64_tr_b16 v[194:195], v227 offset:37376
    v_rcp_f32 v210, v210
    v_rcp_f32 v211, v211
    v_mul_f32 v132, v132, v208
    s_mov_b32 s40, s68
    s_and_b32 s41, s69, 0xffff
    s_mov_b32 s42, 401408
    s_and_b32 s10, s70, 3
    s_mul_i32 s10, s10, 112
    s_lshl_b32 s11, s24, 3
    s_add_u32 s10, s10, s11
    s_mul_i32 s10, s10, 896
    s_lshl_b32 s11, s71, 7
    s_add_u32 s10, s10, s11
    s_lshl_b32 s11, s34, 30
    s_add_u32 s60, s10, s11
    buffer_load_dword v237, v225, s[40:43], s60 offen
    s_add_u32 s60, s60, 57344
    v_mfma_f32_32x32x16_bf16 v[176:191], v[204:207], v[64:67], v[176:191]
    ds_read_b64_tr_b16 v[196:197], v228 offset:36864
    ds_read_b64_tr_b16 v[198:199], v228 offset:37376
    v_mul_f32 v133, v133, v209
    v_mul_f32 v134, v134, v210
    v_mul_f32 v135, v135, v211
    v_cvt_pk_bf16_f32 v216, v128, v129
    v_cvt_pk_bf16_f32 v217, v130, v131
    s_waitcnt lgkmcnt(4)
    v_mfma_f32_32x32x16_bf16 v[160:175], v[0:3], v[68:71], v[160:175]
    ds_read_b64_tr_b16 v[200:201], v227 offset:38912
    ds_read_b64_tr_b16 v[202:203], v227 offset:39424
    v_cvt_pk_bf16_f32 v218, v132, v133
    v_cvt_pk_bf16_f32 v219, v134, v135
    buffer_store_dwordx4 v[216:219], v224, s[44:47], 0 offen offset:2048 sc1
    v_mul_f32 v208, v144, v235
    v_mul_f32 v209, v145, v235
    v_mfma_f32_32x32x16_bf16 v[176:191], v[4:7], v[68:71], v[176:191]
    ds_read_b64_tr_b16 v[204:205], v228 offset:38912
    ds_read_b64_tr_b16 v[206:207], v228 offset:39424
    v_mul_f32 v210, v146, v235
    v_mul_f32 v211, v147, v235
    v_exp_f32 v208, v208
    v_exp_f32 v209, v209
    s_waitcnt lgkmcnt(4)
    v_mfma_f32_32x32x16_bf16 v[160:175], v[192:195], v[72:75], v[160:175]
    s_waitcnt lgkmcnt(0)
    s_waitcnt vmcnt(5)
    s_barrier
    ds_read_b64_tr_b16 v[0:1], v227 offset:0
    ds_read_b64_tr_b16 v[2:3], v227 offset:512
    v_exp_f32 v210, v210
    v_exp_f32 v211, v211
    v_mul_f32 v144, v144, v152
    v_mfma_f32_32x32x16_bf16 v[176:191], v[196:199], v[72:75], v[176:191]
    ds_read_b64_tr_b16 v[4:5], v228 offset:0
    ds_read_b64_tr_b16 v[6:7], v228 offset:512
    v_mul_f32 v145, v145, v153
    v_mul_f32 v146, v146, v154
    v_mul_f32 v147, v147, v155
    v_fma_f32 v208, v208, v236, v236
    v_fma_f32 v209, v209, v236, v236
    v_mfma_f32_32x32x16_bf16 v[160:175], v[200:203], v[76:79], v[160:175]
    ds_read_b64_tr_b16 v[192:193], v227 offset:2048
    ds_read_b64_tr_b16 v[194:195], v227 offset:2560
    v_fma_f32 v210, v210, v236, v236
    v_fma_f32 v211, v211, v236, v236
    v_rcp_f32 v208, v208
    v_rcp_f32 v209, v209
    buffer_load_dword v237, v225, s[40:43], s60 offen
    s_add_u32 s60, s60, 57344
    v_mfma_f32_32x32x16_bf16 v[176:191], v[204:207], v[76:79], v[176:191]
    ds_read_b64_tr_b16 v[196:197], v228 offset:2048
    ds_read_b64_tr_b16 v[198:199], v228 offset:2560
    v_rcp_f32 v210, v210
    v_rcp_f32 v211, v211
    v_mul_f32 v144, v144, v208
    s_waitcnt lgkmcnt(4)
    v_mfma_f32_32x32x16_bf16 v[160:175], v[0:3], v[80:83], v[160:175]
    ds_read_b64_tr_b16 v[200:201], v227 offset:4096
    ds_read_b64_tr_b16 v[202:203], v227 offset:4608
    v_mul_f32 v145, v145, v209
    v_mul_f32 v146, v146, v210
    v_mul_f32 v147, v147, v211
    v_mul_f32 v208, v148, v235
    v_mul_f32 v209, v149, v235
    v_mfma_f32_32x32x16_bf16 v[176:191], v[4:7], v[80:83], v[176:191]
    ds_read_b64_tr_b16 v[204:205], v228 offset:4096
    ds_read_b64_tr_b16 v[206:207], v228 offset:4608
    v_mul_f32 v210, v150, v235
    v_mul_f32 v211, v151, v235
    v_exp_f32 v208, v208
    v_exp_f32 v209, v209
    s_waitcnt lgkmcnt(4)
    v_mfma_f32_32x32x16_bf16 v[160:175], v[192:195], v[84:87], v[160:175]
    ds_read_b64_tr_b16 v[0:1], v227 offset:6144
    ds_read_b64_tr_b16 v[2:3], v227 offset:6656
    v_exp_f32 v210, v210
    v_exp_f32 v211, v211
    v_mul_f32 v148, v148, v156
    v_mfma_f32_32x32x16_bf16 v[176:191], v[196:199], v[84:87], v[176:191]
    ds_read_b64_tr_b16 v[4:5], v228 offset:6144
    ds_read_b64_tr_b16 v[6:7], v228 offset:6656
    v_mul_f32 v149, v149, v157
    v_mul_f32 v150, v150, v158
    v_mul_f32 v151, v151, v159
    v_fma_f32 v208, v208, v236, v236
    v_fma_f32 v209, v209, v236, v236
    s_waitcnt lgkmcnt(4)
    v_mfma_f32_32x32x16_bf16 v[160:175], v[200:203], v[88:91], v[160:175]
    s_waitcnt lgkmcnt(0)
    s_waitcnt vmcnt(3)
    s_barrier
    ds_read_b64_tr_b16 v[192:193], v227 offset:16384
    ds_read_b64_tr_b16 v[194:195], v227 offset:16896
    v_fma_f32 v210, v210, v236, v236
    v_fma_f32 v211, v211, v236, v236
    v_rcp_f32 v208, v208
    v_rcp_f32 v209, v209
    v_mfma_f32_32x32x16_bf16 v[176:191], v[204:207], v[88:91], v[176:191]
    ds_read_b64_tr_b16 v[196:197], v228 offset:16384
    ds_read_b64_tr_b16 v[198:199], v228 offset:16896
    v_rcp_f32 v210, v210
    v_rcp_f32 v211, v211
    v_mul_f32 v148, v148, v208
    v_mfma_f32_32x32x16_bf16 v[160:175], v[0:3], v[92:95], v[160:175]
    ds_read_b64_tr_b16 v[200:201], v227 offset:18432
    ds_read_b64_tr_b16 v[202:203], v227 offset:18944
    v_mul_f32 v149, v149, v209
    v_mul_f32 v150, v150, v210
    v_mul_f32 v151, v151, v211
    v_cvt_pk_bf16_f32 v216, v144, v145
    v_cvt_pk_bf16_f32 v217, v146, v147
    v_mfma_f32_32x32x16_bf16 v[176:191], v[4:7], v[92:95], v[176:191]
    ds_read_b64_tr_b16 v[204:205], v228 offset:18432
    ds_read_b64_tr_b16 v[206:207], v228 offset:18944
    v_cvt_pk_bf16_f32 v218, v148, v149
    v_cvt_pk_bf16_f32 v219, v150, v151
    buffer_store_dwordx4 v[216:219], v224, s[44:47], 0 offen offset:3072 sc1
    s_mul_i32 s29, s28, 1280
    s_mov_b32 s31, 2
    s_lshl_b32 s31, s31, 6
    s_add_u32 s29, s29, s31
    s_add_u32 s29, s29, 65792
    v_and_b32 v247, 15, v226
    v_lshl_add_u32 v247, v247, 2, s29
    s_waitcnt lgkmcnt(4)
    v_mfma_f32_32x32x16_bf16 v[160:175], v[192:195], v[96:99], v[160:175]
    ds_read_b64_tr_b16 v[0:1], v227 offset:20480
    ds_read_b64_tr_b16 v[2:3], v227 offset:20992
    v_bfe_u32 v253, v226, 4, 1
    v_lshl_add_u32 v247, v253, 9, v247
    buffer_load_dword v231, v247, s[44:47], 0 offen sc1
    s_mul_i32 s29, s28, 1280
    s_mov_b32 s31, 3
    s_lshl_b32 s31, s31, 6
    s_add_u32 s29, s29, s31
    s_add_u32 s29, s29, 65792
    v_and_b32 v247, 15, v226
    v_lshl_add_u32 v247, v247, 2, s29
    v_mfma_f32_32x32x16_bf16 v[176:191], v[196:199], v[96:99], v[176:191]
    ds_read_b64_tr_b16 v[4:5], v228 offset:20480
    ds_read_b64_tr_b16 v[6:7], v228 offset:20992
    v_bfe_u32 v253, v226, 4, 1
    v_lshl_add_u32 v247, v253, 9, v247
    buffer_load_dword v232, v247, s[44:47], 0 offen sc1
    s_waitcnt lgkmcnt(4)
    v_mfma_f32_32x32x16_bf16 v[160:175], v[200:203], v[100:103], v[160:175]
    ds_read_b64_tr_b16 v[192:193], v227 offset:22528
    ds_read_b64_tr_b16 v[194:195], v227 offset:23040
    v_mfma_f32_32x32x16_bf16 v[176:191], v[204:207], v[100:103], v[176:191]
    ds_read_b64_tr_b16 v[196:197], v228 offset:22528
    ds_read_b64_tr_b16 v[198:199], v228 offset:23040
    s_waitcnt lgkmcnt(4)
    v_mfma_f32_32x32x16_bf16 v[160:175], v[0:3], v[104:107], v[160:175]
    v_mfma_f32_32x32x16_bf16 v[176:191], v[4:7], v[104:107], v[176:191]
    s_waitcnt lgkmcnt(0)
    v_mfma_f32_32x32x16_bf16 v[160:175], v[192:195], v[108:111], v[160:175]
    v_mfma_f32_32x32x16_bf16 v[176:191], v[196:199], v[108:111], v[176:191]
    s_setprio 0
    s_waitcnt lgkmcnt(0)
    s_barrier
    s_waitcnt vmcnt(3)
    v_lshrrev_b32 v246, 3, v226
    v_and_b32 v247, 7, v226
    v_bfe_u32 v248, v226, 4, 1
    v_lshlrev_b32 v248, 2, v248
    v_xor_b32 v247, v247, v248
    v_mul_u32_u24 v246, 896, v246
    v_lshl_add_u32 v237, v247, 4, v246
    s_lshl_b32 s29, s71, 7
    s_mul_i32 s30, s25, 7168
    s_add_u32 s29, s29, s30
    s_mul_i32 s35, s26, 544768
    s_cmp_eq_u32 s26, 3
    s_cselect_b32 s35, 0, s35
    s_cselect_b32 s12, s68, s64
    s_cselect_b32 s13, s69, s65
    s_cselect_b32 s36, 3584, 0
    s_mov_b32 s14, 1605632
    s_cselect_b32 s14, 401408, s14
    s_add_u32 s35, s35, s29
    s_and_b32 s13, s13, 0xffff
    s_mov_b32 s15, 0x20000
    s_mul_i32 s37, s26, 38912
    s_lshl_b32 s30, s25, 10
    s_add_u32 s37, s37, s30
    s_lshl_b32 s72, s71, 2
    s_mov_b32 s30, 38
    s_cmp_eq_u32 s26, 2
    s_cselect_b32 s30, 36, s30
    s_sub_u32 s73, s30, s72
    s_mul_i32 s74, s30, 14336
    s_sub_u32 s74, 14336, s74
    s_lshl_b32 s75, s30, 10
    s_sub_u32 s75, 1024, s75
    s_cmp_eq_u32 s26, 3
    s_cselect_b32 s72, 0, s72
    s_cselect_b32 s73, 255, s73
    s_lshl_b32 s76, s72, 10
    s_mul_i32 s29, s72, 14336
    s_add_u32 s38, s35, s29
    s_mov_b32 m0, s37
    s_nop 0
    buffer_load_dwordx4 v237, s[12:15], s38 offen lds
    s_add_u32 m0, m0, 2048
    s_add_u32 s38, s38, 14336
    buffer_load_dwordx4 v237, s[12:15], s38 offen lds
    s_add_u32 m0, m0, 2048
    s_add_u32 s38, s38, 14336
    s_sub_u32 s38, s38, s36
    buffer_load_dwordx4 v237, s[12:15], s38 offen lds
    s_add_u32 m0, m0, 2048
    s_add_u32 s38, s38, 14336
    buffer_load_dwordx4 v237, s[12:15], s38 offen lds
    s_add_u32 m0, m0, 2048
    s_add_u32 s38, s38, 14336
    s_sub_u32 s38, s38, s36
    buffer_load_dwordx4 v237, s[12:15], s38 offen lds
    s_add_u32 m0, m0, 2048
    s_add_u32 s38, s38, 14336
    buffer_load_dwordx4 v237, s[12:15], s38 offen lds
    s_add_u32 m0, m0, 2048
    s_add_u32 s38, s38, 14336
    s_sub_u32 s38, s38, s36
    buffer_load_dwordx4 v237, s[12:15], s38 offen lds
    s_add_u32 m0, m0, 2048
    s_add_u32 s38, s38, 14336
    buffer_load_dwordx4 v237, s[12:15], s38 offen lds
    s_add_u32 m0, m0, 2048
    s_add_u32 s38, s38, 14336
    s_sub_u32 s38, s38, s36
    s_waitcnt vmcnt(8)
    v_cndmask_b32 v231, 0, v231, s[90:91]
    v_and_b32 v246, s3, v231
    v_sub_f32 v231, v231, v246
    v_and_b32 v247, s3, v231
    v_lshrrev_b32 v246, 16, v246
    v_sub_f32 v231, v231, v247
    v_or_b32 v242, v246, v247
    v_lshrrev_b32 v243, 16, v231
    s_nop 1
    v_mfma_f32_32x32x16_bf16 v[160:175], v[242:245], v[238:241], v[160:175]
    v_cndmask_b32 v232, 0, v232, s[90:91]
    v_and_b32 v246, s3, v232
    v_sub_f32 v232, v232, v246
    v_and_b32 v247, s3, v232
    v_lshrrev_b32 v246, 16, v246
    v_sub_f32 v232, v232, v247
    v_or_b32 v242, v246, v247
    v_lshrrev_b32 v243, 16, v232
    s_nop 1
    v_mfma_f32_32x32x16_bf16 v[176:191], v[242:245], v[238:241], v[176:191]
    s_lshl_b32 s29, s25, 11
    s_add_u32 s29, s29, 4096
    v_add_u32 v224, s29, v224
    s_nop 12
    v_pk_mul_f32 v[208:209], v[160:161], v[234:235] op_sel:[0,1] op_sel_hi:[1,1]
    v_pk_mul_f32 v[210:211], v[162:163], v[234:235] op_sel:[0,1] op_sel_hi:[1,1]
    v_pk_mul_f32 v[212:213], v[164:165], v[234:235] op_sel:[0,1] op_sel_hi:[1,1]
    v_pk_mul_f32 v[214:215], v[166:167], v[234:235] op_sel:[0,1] op_sel_hi:[1,1]
    v_exp_f32 v208, v208
    v_exp_f32 v209, v209
    v_exp_f32 v210, v210
    v_exp_f32 v211, v211
    v_exp_f32 v212, v212
    v_exp_f32 v213, v213
    v_exp_f32 v214, v214
    v_exp_f32 v215, v215
    v_pk_mul_f32 v[160:161], v[160:161], v[168:169]
    v_pk_mul_f32 v[162:163], v[162:163], v[170:171]
    v_pk_mul_f32 v[164:165], v[164:165], v[172:173]
    v_pk_mul_f32 v[166:167], v[166:167], v[174:175]
    v_pk_fma_f32 v[208:209], v[208:209], v[236:237], v[236:237] op_sel_hi:[1,0,0]
    v_pk_fma_f32 v[210:211], v[210:211], v[236:237], v[236:237] op_sel_hi:[1,0,0]
    v_pk_fma_f32 v[212:213], v[212:213], v[236:237], v[236:237] op_sel_hi:[1,0,0]
    v_pk_fma_f32 v[214:215], v[214:215], v[236:237], v[236:237] op_sel_hi:[1,0,0]
    v_rcp_f32 v208, v208
    v_rcp_f32 v209, v209
    v_rcp_f32 v210, v210
    v_rcp_f32 v211, v211
    v_rcp_f32 v212, v212
    v_rcp_f32 v213, v213
    v_rcp_f32 v214, v214
    v_rcp_f32 v215, v215
    v_pk_mul_f32 v[160:161], v[160:161], v[208:209]
    v_pk_mul_f32 v[162:163], v[162:163], v[210:211]
    v_pk_mul_f32 v[164:165], v[164:165], v[212:213]
    v_pk_mul_f32 v[166:167], v[166:167], v[214:215]
    v_cvt_pk_bf16_f32 v216, v160, v161
    v_cvt_pk_bf16_f32 v217, v162, v163
    v_cvt_pk_bf16_f32 v218, v164, v165
    v_cvt_pk_bf16_f32 v219, v166, v167
    buffer_store_dwordx4 v[216:219], v224, s[44:47], 0 offen offset:0 sc1
    v_pk_mul_f32 v[208:209], v[176:177], v[234:235] op_sel:[0,1] op_sel_hi:[1,1]
    v_pk_mul_f32 v[210:211], v[178:179], v[234:235] op_sel:[0,1] op_sel_hi:[1,1]
    v_pk_mul_f32 v[212:213], v[180:181], v[234:235] op_sel:[0,1] op_sel_hi:[1,1]
    v_pk_mul_f32 v[214:215], v[182:183], v[234:235] op_sel:[0,1] op_sel_hi:[1,1]
    v_exp_f32 v208, v208
    v_exp_f32 v209, v209
    v_exp_f32 v210, v210
    v_exp_f32 v211, v211
    v_exp_f32 v212, v212
    v_exp_f32 v213, v213
    v_exp_f32 v214, v214
    v_exp_f32 v215, v215
    v_pk_mul_f32 v[176:177], v[176:177], v[184:185]
    v_pk_mul_f32 v[178:179], v[178:179], v[186:187]
    v_pk_mul_f32 v[180:181], v[180:181], v[188:189]
    v_pk_mul_f32 v[182:183], v[182:183], v[190:191]
    v_pk_fma_f32 v[208:209], v[208:209], v[236:237], v[236:237] op_sel_hi:[1,0,0]
    v_pk_fma_f32 v[210:211], v[210:211], v[236:237], v[236:237] op_sel_hi:[1,0,0]
    v_pk_fma_f32 v[212:213], v[212:213], v[236:237], v[236:237] op_sel_hi:[1,0,0]
    v_pk_fma_f32 v[214:215], v[214:215], v[236:237], v[236:237] op_sel_hi:[1,0,0]
    v_rcp_f32 v208, v208
    v_rcp_f32 v209, v209
    v_rcp_f32 v210, v210
    v_rcp_f32 v211, v211
    v_rcp_f32 v212, v212
    v_rcp_f32 v213, v213
    v_rcp_f32 v214, v214
    v_rcp_f32 v215, v215
    v_pk_mul_f32 v[176:177], v[176:177], v[208:209]
    v_pk_mul_f32 v[178:179], v[178:179], v[210:211]
    v_pk_mul_f32 v[180:181], v[180:181], v[212:213]
    v_pk_mul_f32 v[182:183], v[182:183], v[214:215]
    v_cvt_pk_bf16_f32 v216, v176, v177
    v_cvt_pk_bf16_f32 v217, v178, v179
    v_cvt_pk_bf16_f32 v218, v180, v181
    v_cvt_pk_bf16_f32 v219, v182, v183
    buffer_store_dwordx4 v[216:219], v224, s[44:47], 0 offen offset:1024 sc1
    buffer_load_dwordx4 v237, s[12:15], s38 offen lds
    s_add_u32 m0, m0, 2048
    s_add_u32 s38, s38, 14336
    buffer_load_dwordx4 v237, s[12:15], s38 offen lds
    s_add_u32 m0, m0, 2048
    s_add_u32 s38, s38, 14336
    s_sub_u32 s38, s38, s36
    buffer_load_dwordx4 v237, s[12:15], s38 offen lds
    s_add_u32 m0, m0, 2048
    s_add_u32 s38, s38, 14336
    buffer_load_dwordx4 v237, s[12:15], s38 offen lds
    s_add_u32 m0, m0, 2048
    s_cmp_eq_u32 s73, 12
    s_cselect_b32 s29, s74, 14336
    s_add_u32 s38, s38, s29
    s_sub_u32 s38, s38, s36
    buffer_load_dwordx4 v237, s[12:15], s38 offen lds
    s_add_u32 m0, m0, 2048
    s_cmp_eq_u32 s73, 13
    s_cselect_b32 s29, s74, 14336
    s_add_u32 s38, s38, s29
    buffer_load_dwordx4 v237, s[12:15], s38 offen lds
    s_add_u32 m0, m0, 2048
    s_cmp_eq_u32 s73, 14
    s_cselect_b32 s29, s74, 14336
    s_add_u32 s38, s38, s29
    s_sub_u32 s38, s38, s36
    buffer_load_dwordx4 v237, s[12:15], s38 offen lds
    s_add_u32 m0, m0, 2048
    s_cmp_eq_u32 s73, 15
    s_cselect_b32 s29, s74, 14336
    s_add_u32 s38, s38, s29
    buffer_load_dwordx4 v237, s[12:15], s38 offen lds
    s_add_u32 m0, m0, 2048
    s_cmp_eq_u32 s73, 16
    s_cselect_b32 s29, s74, 14336
    s_add_u32 s38, s38, s29
    s_sub_u32 s38, s38, s36
    buffer_load_dwordx4 v237, s[12:15], s38 offen lds
    s_add_u32 m0, m0, 2048
    s_cmp_eq_u32 s73, 17
    s_cselect_b32 s29, s74, 14336
    s_add_u32 s38, s38, s29
    buffer_load_dwordx4 v237, s[12:15], s38 offen lds
    s_add_u32 m0, m0, 2048
    s_cmp_eq_u32 s73, 18
    s_cselect_b32 s29, s74, 14336
    s_add_u32 s38, s38, s29
    s_sub_u32 s38, s38, s36
    buffer_load_dwordx4 v237, s[12:15], s38 offen lds
    s_add_u32 m0, m0, 2048
    s_cmp_eq_u32 s73, 19
    s_cselect_b32 s29, s74, 14336
    s_add_u32 s38, s38, s29
    s_mov_b32 s16, s66
    s_and_b32 s17, s67, 0xffff
    s_mov_b32 s18, 1835008
    s_mov_b32 s19, 0x20000
    s_mov_b32 s20, s4
    s_and_b32 s21, s5, 0xffff
    s_mov_b32 s22, 1835008
    s_mov_b32 s23, 0x20000
    v_lshrrev_b32 v240, 5, v226
    v_lshlrev_b32 v240, 2, v240
    v_bfe_u32 v241, v226, 2, 2
    v_add_u32 v240, v240, v241
    v_lshlrev_b32 v240, 7, v240
    v_bfe_u32 v241, v226, 4, 1
    v_lshl_add_u32 v240, v241, 5, v240
    v_and_b32 v241, 3, v226
    v_lshl_add_u32 v240, v241, 3, v240
    v_bfe_u32 v241, v226, 3, 1
    v_lshl_add_u32 v232, v241, 6, v240
    v_xor_b32 v241, 1, v241
    v_lshl_add_u32 v233, v241, 6, v240
    s_mul_i32 s29, s26, 38912
    v_add_u32 v232, s29, v232
    v_add_u32 v233, s29, v233
    s_lshl_b32 s29, s70, 1
    s_add_u32 s29, s29, s25
    s_mul_i32 s29, s29, 144
    s_mul_i32 s30, s26, 38
    s_cmp_eq_u32 s26, 3
    s_cselect_b32 s30, 112, s30
    s_add_u32 s29, s29, s30
    s_lshl_b32 s29, s29, 10
    s_add_u32 s29, s29, 1048576
    v_lshlrev_b32 v240, 4, v226
    v_add_u32 v234, s29, v240
    s_lshl_b32 s29, s25, 15
    v_add_u32 v236, s29, v240
    s_lshl_b32 s29, s70, 6
    s_lshl_b32 s30, s25, 5
    s_add_u32 s29, s29, s30
    v_and_b32 v240, 31, v226
    v_add_u32 v240, s29, v240
    v_mul_u32_u24 v240, 896, v240
    s_lshl_b32 s29, s71, 7
    s_lshl_b32 s30, s26, 5
    s_add_u32 s29, s29, s30
    v_add_u32 v240, s29, v240
    v_lshrrev_b32 v241, 5, v226
    v_lshl_add_u32 v235, v241, 3, v240
    s_waitcnt vmcnt(0)
    s_barrier
    s_cmp_lg_u32 s24, 0
    s_cbranch_scc1 L_hsig_35
    s_add_u32 s29, s27, 16
    s_lshl_b32 s29, s29, 7
    s_add_u32 s29, s29, 86016
    v_mov_b32 v246, s29
    v_mov_b32 v247, 1
    v_cmp_eq_u32 vcc, 0, v226
    s_and_saveexec_b64 s[30:31], vcc
    buffer_atomic_add v247, v246, s[44:47], 0 offen
    s_mov_b64 exec, s[30:31]
L_hsig_35:
    s_branch L_g2_20
L_go_slow_28:
    s_mov_b32 s31, 0
L_go_100031:
    buffer_load_dword v251, v241, s[52:55], 0 offen sc1
    s_add_u32 s31, s31, 1
    s_waitcnt vmcnt(0)
    v_cmp_gt_u32 vcc, 8, v251
    s_nop 4
    s_cmp_gt_u32 s31, 400000
    s_cbranch_scc1 L_go_done_100032
    s_cbranch_vccz L_go_done_100032
    s_sleep 1
    s_branch L_go_100031
L_go_done_100032:
    s_branch L_go_back_29
L_prew_slow_32:
    s_mov_b32 s31, 0
L_pre_100041:
    buffer_load_dword v254, v253, s[44:47], 0 offen sc1
    s_add_u32 s31, s31, 1
    s_waitcnt vmcnt(0)
    v_cmp_gt_u32 vcc, 16, v254
    s_nop 4
    s_cmp_gt_u32 s31, 400000
    s_cbranch_scc1 L_pre_done_100042
    s_cbranch_vccz L_pre_done_100042
    s_sleep 1
    s_branch L_pre_100041
L_pre_done_100042:
    s_branch L_prew_back_33
L_g1_A_34:
    ds_read_b64_tr_b16 v[192:193], v227 offset:16384
    ds_read_b64_tr_b16 v[194:195], v227 offset:16896
    ds_read_b64_tr_b16 v[196:197], v228 offset:16384
    ds_read_b64_tr_b16 v[198:199], v228 offset:16896
    ds_read_b64_tr_b16 v[200:201], v227 offset:18432
    ds_read_b64_tr_b16 v[202:203], v227 offset:18944
    ds_read_b64_tr_b16 v[204:205], v228 offset:18432
    ds_read_b64_tr_b16 v[206:207], v228 offset:18944
    s_waitcnt lgkmcnt(4)
    v_mfma_f32_32x32x16_bf16 v[160:175], v[192:195], v[0:3], 0
    s_waitcnt vmcnt(6)
    v_xor_b32 v246, 0x8000, v235
    v_mul_f32 v236, v234, v234
    v_rcp_f32 v234, v234
    v_lshl_or_b32 v238, v246, 16, v246
    v_mov_b32 v239, v246
    v_mov_b32 v240, 0
    v_mfma_f32_32x32x16_bf16 v[176:191], v[196:199], v[0:3], 0
    v_mov_b32 v241, 0
    v_mov_b32 v244, 0
    v_mov_b32 v245, 0
    s_mov_b32 s29, 3216550459
    v_mul_f32 v235, s29, v234
    v_mov_b32 v254, 3049366176
    v_mov_b32 v255, s33
    v_cndmask_b32 v231, 0, v231, s[90:91]
    s_waitcnt lgkmcnt(0)
    v_mfma_f32_32x32x16_bf16 v[160:175], v[200:203], v[4:7], v[160:175]
    ds_read_b64_tr_b16 v[192:193], v227 offset:22528
    ds_read_b64_tr_b16 v[194:195], v227 offset:23040
    v_and_b32 v246, s3, v231
    v_sub_f32 v231, v231, v246
    v_and_b32 v247, s3, v231
    v_lshrrev_b32 v246, 16, v246
    v_sub_f32 v231, v231, v247
    v_or_b32 v242, v246, v247
    v_lshrrev_b32 v243, 16, v231
    s_nop 1
    v_mfma_f32_32x32x16_bf16 v[176:191], v[204:207], v[4:7], v[176:191]
    ds_read_b64_tr_b16 v[196:197], v228 offset:22528
    ds_read_b64_tr_b16 v[198:199], v228 offset:23040
    v_mfma_f32_32x32x16_bf16 v[112:127], v[242:245], v[238:241], v[112:127]
    v_cndmask_b32 v232, 0, v232, s[90:91]
    v_and_b32 v246, s3, v232
    v_sub_f32 v232, v232, v246
    v_and_b32 v247, s3, v232
    v_lshrrev_b32 v246, 16, v246
    ds_read_b64_tr_b16 v[0:1], v227 offset:20480
    ds_read_b64_tr_b16 v[2:3], v227 offset:20992
    ds_read_b64_tr_b16 v[4:5], v228 offset:20480
    ds_read_b64_tr_b16 v[6:7], v228 offset:20992
    s_waitcnt lgkmcnt(0)
    v_mfma_f32_32x32x16_bf16 v[160:175], v[0:3], v[8:11], v[160:175]
    s_waitcnt lgkmcnt(0)
    s_waitcnt vmcnt(4)
    s_barrier
    ds_read_b64_tr_b16 v[200:201], v227 offset:32768
    ds_read_b64_tr_b16 v[202:203], v227 offset:33280
    v_sub_f32 v232, v232, v247
    v_or_b32 v242, v246, v247
    v_lshrrev_b32 v243, 16, v232
    s_nop 1
    v_mfma_f32_32x32x16_bf16 v[128:143], v[242:245], v[238:241], v[128:143]
    v_cndmask_b32 v233, 0, v233, s[90:91]
    v_and_b32 v246, s3, v233
    v_mfma_f32_32x32x16_bf16 v[176:191], v[4:7], v[8:11], v[176:191]
    ds_read_b64_tr_b16 v[204:205], v228 offset:32768
    ds_read_b64_tr_b16 v[206:207], v228 offset:33280
    v_sub_f32 v233, v233, v246
    v_and_b32 v247, s3, v233
    v_lshrrev_b32 v246, 16, v246
    v_sub_f32 v233, v233, v247
    v_or_b32 v242, v246, v247
    v_lshrrev_b32 v243, 16, v233
    s_nop 1
    v_mfma_f32_32x32x16_bf16 v[144:159], v[242:245], v[238:241], v[144:159]
    v_mfma_f32_32x32x16_bf16 v[160:175], v[192:195], v[12:15], v[160:175]
    ds_read_b64_tr_b16 v[0:1], v227 offset:34816
    ds_read_b64_tr_b16 v[2:3], v227 offset:35328
    v_fma_f32 v112, v112, v234, v255
    v_fma_f32 v113, v113, v234, v255
    v_fma_f32 v114, v114, v234, v255
    v_fma_f32 v115, v115, v234, v255
    v_fma_f32 v116, v116, v234, v255
    v_fma_f32 v117, v117, v234, v255
    v_fma_f32 v118, v118, v234, v255
    s_add_u32 m0, s62, 65536
    s_nop 0
    buffer_load_dwordx4 v229, s[16:19], s82 offen lds
    s_add_u32 m0, s62, 73728
    v_mfma_f32_32x32x16_bf16 v[176:191], v[196:199], v[12:15], v[176:191]
    ds_read_b64_tr_b16 v[4:5], v228 offset:34816
    ds_read_b64_tr_b16 v[6:7], v228 offset:35328
    v_fma_f32 v119, v119, v234, v255
    v_fma_f32 v208, v112, s93, v254
    v_fma_f32 v209, v113, s93, v254
    v_fma_f32 v210, v114, s93, v254
    v_fma_f32 v211, v115, s93, v254
    v_fma_f32 v212, v116, s93, v254
    v_fma_f32 v213, v117, s93, v254
    buffer_load_dwordx4 v230, s[20:23], s82 offen lds
    s_waitcnt lgkmcnt(4)
    v_mfma_f32_32x32x16_bf16 v[160:175], v[200:203], v[16:19], v[160:175]
    ds_read_b64_tr_b16 v[192:193], v227 offset:36864
    ds_read_b64_tr_b16 v[194:195], v227 offset:37376
    v_fma_f32 v214, v118, s93, v254
    v_fma_f32 v215, v119, s93, v254
    v_exp_f32_e64 v208, v208 clamp
    v_exp_f32_e64 v209, v209 clamp
    v_exp_f32_e64 v210, v210 clamp
    buffer_load_dword v237, v225, s[40:43], s60 offen
    s_add_u32 s60, s60, 57344
    v_mfma_f32_32x32x16_bf16 v[176:191], v[204:207], v[16:19], v[176:191]
    ds_read_b64_tr_b16 v[196:197], v228 offset:36864
    ds_read_b64_tr_b16 v[198:199], v228 offset:37376
    v_exp_f32_e64 v211, v211 clamp
    v_exp_f32_e64 v212, v212 clamp
    v_exp_f32_e64 v213, v213 clamp
    v_exp_f32_e64 v214, v214 clamp
    buffer_load_dword v237, v225, s[40:43], s60 offen
    s_add_u32 s60, s60, 57344
    s_waitcnt lgkmcnt(4)
    v_mfma_f32_32x32x16_bf16 v[160:175], v[0:3], v[20:23], v[160:175]
    ds_read_b64_tr_b16 v[200:201], v227 offset:38912
    ds_read_b64_tr_b16 v[202:203], v227 offset:39424
    v_exp_f32_e64 v215, v215 clamp
    v_max_f32 v112, s33, v112
    v_max_f32 v113, s33, v113
    v_max_f32 v114, s33, v114
    v_max_f32 v115, s33, v115
    v_max_f32 v116, s33, v116
    v_mfma_f32_32x32x16_bf16 v[176:191], v[4:7], v[20:23], v[176:191]
    ds_read_b64_tr_b16 v[204:205], v228 offset:38912
    ds_read_b64_tr_b16 v[206:207], v228 offset:39424
    v_max_f32 v117, s33, v117
    v_max_f32 v118, s33, v118
    v_max_f32 v119, s33, v119
    v_add_f32 v112, v112, v208
    v_add_f32 v113, v113, v209
    v_add_f32 v114, v114, v210
    v_add_f32 v115, v115, v211
    s_waitcnt lgkmcnt(4)
    v_mfma_f32_32x32x16_bf16 v[160:175], v[192:195], v[24:27], v[160:175]
    s_waitcnt lgkmcnt(0)
    s_waitcnt vmcnt(5)
    s_barrier
    ds_read_b64_tr_b16 v[0:1], v227 offset:0
    ds_read_b64_tr_b16 v[2:3], v227 offset:512
    v_add_f32 v116, v116, v212
    v_add_f32 v117, v117, v213
    v_add_f32 v118, v118, v214
    v_add_f32 v119, v119, v215
    v_cvt_pk_bf16_f32 v220, v112, v113
    v_cvt_pk_bf16_f32 v221, v114, v115
    v_cvt_pk_bf16_f32 v222, v116, v117
    v_mfma_f32_32x32x16_bf16 v[176:191], v[196:199], v[24:27], v[176:191]
    ds_read_b64_tr_b16 v[4:5], v228 offset:0
    ds_read_b64_tr_b16 v[6:7], v228 offset:512
    v_cvt_pk_bf16_f32 v223, v118, v119
    v_fma_f32 v120, v120, v234, v255
    v_fma_f32 v121, v121, v234, v255
    v_fma_f32 v122, v122, v234, v255
    v_fma_f32 v123, v123, v234, v255
    v_fma_f32 v124, v124, v234, v255
    v_fma_f32 v125, v125, v234, v255
    v_mfma_f32_32x32x16_bf16 v[160:175], v[200:203], v[28:31], v[160:175]
    ds_read_b64_tr_b16 v[192:193], v227 offset:2048
    ds_read_b64_tr_b16 v[194:195], v227 offset:2560
    v_fma_f32 v126, v126, v234, v255
    v_fma_f32 v127, v127, v234, v255
    v_fma_f32 v208, v120, s93, v254
    v_fma_f32 v209, v121, s93, v254
    v_fma_f32 v210, v122, s93, v254
    v_fma_f32 v211, v123, s93, v254
    v_fma_f32 v212, v124, s93, v254
    s_add_u32 m0, s62, 81920
    s_nop 0
    buffer_load_dwordx4 v229, s[16:19], s83 offen lds
    s_add_u32 m0, s62, 90112
    v_mfma_f32_32x32x16_bf16 v[176:191], v[204:207], v[28:31], v[176:191]
    ds_read_b64_tr_b16 v[196:197], v228 offset:2048
    ds_read_b64_tr_b16 v[198:199], v228 offset:2560
    v_fma_f32 v213, v125, s93, v254
    v_fma_f32 v214, v126, s93, v254
    v_fma_f32 v215, v127, s93, v254
    v_exp_f32_e64 v208, v208 clamp
    v_exp_f32_e64 v209, v209 clamp
    buffer_load_dwordx4 v230, s[20:23], s83 offen lds
    s_waitcnt lgkmcnt(4)
    v_mfma_f32_32x32x16_bf16 v[160:175], v[0:3], v[32:35], v[160:175]
    ds_read_b64_tr_b16 v[200:201], v227 offset:4096
    ds_read_b64_tr_b16 v[202:203], v227 offset:4608
    v_exp_f32_e64 v210, v210 clamp
    v_exp_f32_e64 v211, v211 clamp
    v_exp_f32_e64 v212, v212 clamp
    v_exp_f32_e64 v213, v213 clamp
    buffer_load_dword v237, v225, s[40:43], s60 offen
    s_add_u32 s60, s60, 57344
    v_mfma_f32_32x32x16_bf16 v[176:191], v[4:7], v[32:35], v[176:191]
    ds_read_b64_tr_b16 v[204:205], v228 offset:4096
    ds_read_b64_tr_b16 v[206:207], v228 offset:4608
    v_exp_f32_e64 v214, v214 clamp
    v_exp_f32_e64 v215, v215 clamp
    v_max_f32 v120, s33, v120
    v_max_f32 v121, s33, v121
    v_max_f32 v122, s33, v122
    buffer_load_dword v237, v225, s[40:43], s60 offen
    s_add_u32 s60, s60, 57344
    s_waitcnt lgkmcnt(4)
    v_mfma_f32_32x32x16_bf16 v[160:175], v[192:195], v[36:39], v[160:175]
    ds_read_b64_tr_b16 v[0:1], v227 offset:6144
    ds_read_b64_tr_b16 v[2:3], v227 offset:6656
    v_max_f32 v123, s33, v123
    v_max_f32 v124, s33, v124
    v_max_f32 v125, s33, v125
    v_max_f32 v126, s33, v126
    v_max_f32 v127, s33, v127
    v_add_f32 v120, v120, v208
    v_add_f32 v121, v121, v209
    v_mfma_f32_32x32x16_bf16 v[176:191], v[196:199], v[36:39], v[176:191]
    ds_read_b64_tr_b16 v[4:5], v228 offset:6144
    ds_read_b64_tr_b16 v[6:7], v228 offset:6656
    v_add_f32 v122, v122, v210
    v_add_f32 v123, v123, v211
    v_add_f32 v124, v124, v212
    v_add_f32 v125, v125, v213
    v_add_f32 v126, v126, v214
    v_add_f32 v127, v127, v215
    v_cvt_pk_bf16_f32 v116, v120, v121
    s_waitcnt lgkmcnt(4)
    v_mfma_f32_32x32x16_bf16 v[160:175], v[200:203], v[40:43], v[160:175]
    s_waitcnt lgkmcnt(0)
    s_waitcnt vmcnt(6)
    s_barrier
    ds_read_b64_tr_b16 v[192:193], v227 offset:16384
    ds_read_b64_tr_b16 v[194:195], v227 offset:16896
    v_cvt_pk_bf16_f32 v117, v122, v123
    v_cvt_pk_bf16_f32 v118, v124, v125
    v_cvt_pk_bf16_f32 v119, v126, v127
    v_mov_b32 v112, v220
    v_mov_b32 v113, v221
    v_mov_b32 v114, v222
    v_mov_b32 v115, v223
    v_mfma_f32_32x32x16_bf16 v[176:191], v[204:207], v[40:43], v[176:191]
    ds_read_b64_tr_b16 v[196:197], v228 offset:16384
    ds_read_b64_tr_b16 v[198:199], v228 offset:16896
    v_fma_f32 v128, v128, v234, v255
    v_fma_f32 v129, v129, v234, v255
    v_fma_f32 v130, v130, v234, v255
    v_fma_f32 v131, v131, v234, v255
    v_fma_f32 v132, v132, v234, v255
    v_fma_f32 v133, v133, v234, v255
    v_fma_f32 v134, v134, v234, v255
    v_mfma_f32_32x32x16_bf16 v[160:175], v[0:3], v[44:47], v[160:175]
    ds_read_b64_tr_b16 v[200:201], v227 offset:18432
    ds_read_b64_tr_b16 v[202:203], v227 offset:18944
    v_fma_f32 v135, v135, v234, v255
    v_fma_f32 v208, v128, s93, v254
    v_fma_f32 v209, v129, s93, v254
    v_fma_f32 v210, v130, s93, v254
    v_fma_f32 v211, v131, s93, v254
    v_fma_f32 v212, v132, s93, v254
    v_fma_f32 v213, v133, s93, v254
    s_add_u32 m0, s62, 49152
    s_nop 0
    buffer_load_dwordx4 v229, s[16:19], s84 offen lds
    s_add_u32 m0, s62, 57344
    v_mfma_f32_32x32x16_bf16 v[176:191], v[4:7], v[44:47], v[176:191]
    ds_read_b64_tr_b16 v[204:205], v228 offset:18432
    ds_read_b64_tr_b16 v[206:207], v228 offset:18944
    v_fma_f32 v214, v134, s93, v254
    v_fma_f32 v215, v135, s93, v254
    v_exp_f32_e64 v208, v208 clamp
    v_exp_f32_e64 v209, v209 clamp
    v_exp_f32_e64 v210, v210 clamp
    buffer_load_dwordx4 v230, s[20:23], s84 offen lds
    s_waitcnt lgkmcnt(4)
    v_mfma_f32_32x32x16_bf16 v[160:175], v[192:195], v[48:51], v[160:175]
    ds_read_b64_tr_b16 v[0:1], v227 offset:20480
    ds_read_b64_tr_b16 v[2:3], v227 offset:20992
    v_exp_f32_e64 v211, v211 clamp
    v_exp_f32_e64 v212, v212 clamp
    v_exp_f32_e64 v213, v213 clamp
    v_exp_f32_e64 v214, v214 clamp
    buffer_load_dword v237, v225, s[40:43], s60 offen
    s_add_u32 s60, s60, 57344
    v_mfma_f32_32x32x16_bf16 v[176:191], v[196:199], v[48:51], v[176:191]
    ds_read_b64_tr_b16 v[4:5], v228 offset:20480
    ds_read_b64_tr_b16 v[6:7], v228 offset:20992
    v_exp_f32_e64 v215, v215 clamp
    v_max_f32 v128, s33, v128
    v_max_f32 v129, s33, v129
    v_max_f32 v130, s33, v130
    v_max_f32 v131, s33, v131
    v_max_f32 v132, s33, v132
    s_waitcnt lgkmcnt(4)
    v_mfma_f32_32x32x16_bf16 v[160:175], v[200:203], v[52:55], v[160:175]
    ds_read_b64_tr_b16 v[192:193], v227 offset:22528
    ds_read_b64_tr_b16 v[194:195], v227 offset:23040
    v_max_f32 v133, s33, v133
    v_max_f32 v134, s33, v134
    v_max_f32 v135, s33, v135
    v_add_f32 v128, v128, v208
    v_add_f32 v129, v129, v209
    v_add_f32 v130, v130, v210
    v_add_f32 v131, v131, v211
    v_mfma_f32_32x32x16_bf16 v[176:191], v[204:207], v[52:55], v[176:191]
    ds_read_b64_tr_b16 v[196:197], v228 offset:22528
    ds_read_b64_tr_b16 v[198:199], v228 offset:23040
    v_add_f32 v132, v132, v212
    v_add_f32 v133, v133, v213
    v_add_f32 v134, v134, v214
    v_add_f32 v135, v135, v215
    v_cvt_pk_bf16_f32 v220, v128, v129
    v_cvt_pk_bf16_f32 v221, v130, v131
    v_cvt_pk_bf16_f32 v222, v132, v133
    s_waitcnt lgkmcnt(4)
    v_mfma_f32_32x32x16_bf16 v[160:175], v[0:3], v[56:59], v[160:175]
    s_waitcnt lgkmcnt(0)
    s_waitcnt vmcnt(5)
    s_barrier
    ds_read_b64_tr_b16 v[200:201], v227 offset:32768
    ds_read_b64_tr_b16 v[202:203], v227 offset:33280
    v_cvt_pk_bf16_f32 v223, v134, v135
    v_fma_f32 v136, v136, v234, v255
    v_fma_f32 v137, v137, v234, v255
    v_fma_f32 v138, v138, v234, v255
    v_fma_f32 v139, v139, v234, v255
    v_fma_f32 v140, v140, v234, v255
    v_fma_f32 v141, v141, v234, v255
    v_mfma_f32_32x32x16_bf16 v[176:191], v[4:7], v[56:59], v[176:191]
    ds_read_b64_tr_b16 v[204:205], v228 offset:32768
    ds_read_b64_tr_b16 v[206:207], v228 offset:33280
    v_fma_f32 v142, v142, v234, v255
    v_fma_f32 v143, v143, v234, v255
    v_fma_f32 v208, v136, s93, v254
    v_fma_f32 v209, v137, s93, v254
    v_fma_f32 v210, v138, s93, v254
    v_fma_f32 v211, v139, s93, v254
    v_fma_f32 v212, v140, s93, v254
    v_mfma_f32_32x32x16_bf16 v[160:175], v[192:195], v[60:63], v[160:175]
    ds_read_b64_tr_b16 v[0:1], v227 offset:34816
    ds_read_b64_tr_b16 v[2:3], v227 offset:35328
    v_fma_f32 v213, v141, s93, v254
    v_fma_f32 v214, v142, s93, v254
    v_fma_f32 v215, v143, s93, v254
    v_exp_f32_e64 v208, v208 clamp
    v_exp_f32_e64 v209, v209 clamp
    s_add_u32 m0, s62, 65536
    s_nop 0
    buffer_load_dwordx4 v229, s[16:19], s85 offen lds
    s_add_u32 m0, s62, 73728
    v_mfma_f32_32x32x16_bf16 v[176:191], v[196:199], v[60:63], v[176:191]
    ds_read_b64_tr_b16 v[4:5], v228 offset:34816
    ds_read_b64_tr_b16 v[6:7], v228 offset:35328
    v_exp_f32_e64 v210, v210 clamp
    v_exp_f32_e64 v211, v211 clamp
    v_exp_f32_e64 v212, v212 clamp
    v_exp_f32_e64 v213, v213 clamp
    buffer_load_dwordx4 v230, s[20:23], s85 offen lds
    s_waitcnt lgkmcnt(4)
    v_mfma_f32_32x32x16_bf16 v[160:175], v[200:203], v[64:67], v[160:175]
    ds_read_b64_tr_b16 v[192:193], v227 offset:36864
    ds_read_b64_tr_b16 v[194:195], v227 offset:37376
    v_exp_f32_e64 v214, v214 clamp
    v_exp_f32_e64 v215, v215 clamp
    v_max_f32 v136, s33, v136
    v_max_f32 v137, s33, v137
    v_max_f32 v138, s33, v138
    s_mov_b32 s40, s68
    s_and_b32 s41, s69, 0xffff
    s_mov_b32 s42, 401408
    s_and_b32 s10, s70, 3
    s_mul_i32 s10, s10, 112
    s_lshl_b32 s11, s24, 3
    s_add_u32 s10, s10, s11
    s_mul_i32 s10, s10, 896
    s_lshl_b32 s11, s71, 7
    s_add_u32 s10, s10, s11
    s_lshl_b32 s11, s34, 30
    s_add_u32 s60, s10, s11
    buffer_load_dword v237, v225, s[40:43], s60 offen
    s_add_u32 s60, s60, 57344
    v_mfma_f32_32x32x16_bf16 v[176:191], v[204:207], v[64:67], v[176:191]
    ds_read_b64_tr_b16 v[196:197], v228 offset:36864
    ds_read_b64_tr_b16 v[198:199], v228 offset:37376
    v_max_f32 v139, s33, v139
    v_max_f32 v140, s33, v140
    v_max_f32 v141, s33, v141
    v_max_f32 v142, s33, v142
    v_max_f32 v143, s33, v143
    v_add_f32 v136, v136, v208
    v_add_f32 v137, v137, v209
    s_waitcnt lgkmcnt(4)
    v_mfma_f32_32x32x16_bf16 v[160:175], v[0:3], v[68:71], v[160:175]
    ds_read_b64_tr_b16 v[200:201], v227 offset:38912
    ds_read_b64_tr_b16 v[202:203], v227 offset:39424
    v_add_f32 v138, v138, v210
    v_add_f32 v139, v139, v211
    v_add_f32 v140, v140, v212
    v_add_f32 v141, v141, v213
    v_add_f32 v142, v142, v214
    v_add_f32 v143, v143, v215
    v_cvt_pk_bf16_f32 v132, v136, v137
    v_mfma_f32_32x32x16_bf16 v[176:191], v[4:7], v[68:71], v[176:191]
    ds_read_b64_tr_b16 v[204:205], v228 offset:38912
    ds_read_b64_tr_b16 v[206:207], v228 offset:39424
    v_cvt_pk_bf16_f32 v133, v138, v139
    v_cvt_pk_bf16_f32 v134, v140, v141
    v_cvt_pk_bf16_f32 v135, v142, v143
    v_mov_b32 v128, v220
    v_mov_b32 v129, v221
    v_mov_b32 v130, v222
    v_mov_b32 v131, v223
    s_waitcnt lgkmcnt(4)
    v_mfma_f32_32x32x16_bf16 v[160:175], v[192:195], v[72:75], v[160:175]
    s_waitcnt lgkmcnt(0)
    s_waitcnt vmcnt(4)
    s_barrier
    ds_read_b64_tr_b16 v[0:1], v227 offset:0
    ds_read_b64_tr_b16 v[2:3], v227 offset:512
    v_fma_f32 v144, v144, v234, v255
    v_fma_f32 v145, v145, v234, v255
    v_fma_f32 v146, v146, v234, v255
    v_fma_f32 v147, v147, v234, v255
    v_fma_f32 v148, v148, v234, v255
    v_fma_f32 v149, v149, v234, v255
    v_fma_f32 v150, v150, v234, v255
    v_mfma_f32_32x32x16_bf16 v[176:191], v[196:199], v[72:75], v[176:191]
    ds_read_b64_tr_b16 v[4:5], v228 offset:0
    ds_read_b64_tr_b16 v[6:7], v228 offset:512
    v_fma_f32 v151, v151, v234, v255
    v_fma_f32 v208, v144, s93, v254
    v_fma_f32 v209, v145, s93, v254
    v_fma_f32 v210, v146, s93, v254
    v_fma_f32 v211, v147, s93, v254
    v_fma_f32 v212, v148, s93, v254
    v_fma_f32 v213, v149, s93, v254
    v_mfma_f32_32x32x16_bf16 v[160:175], v[200:203], v[76:79], v[160:175]
    ds_read_b64_tr_b16 v[192:193], v227 offset:2048
    ds_read_b64_tr_b16 v[194:195], v227 offset:2560
    v_fma_f32 v214, v150, s93, v254
    v_fma_f32 v215, v151, s93, v254
    v_exp_f32_e64 v208, v208 clamp
    v_exp_f32_e64 v209, v209 clamp
    v_exp_f32_e64 v210, v210 clamp
    buffer_load_dword v237, v225, s[40:43], s60 offen
    s_add_u32 s60, s60, 57344
    v_mfma_f32_32x32x16_bf16 v[176:191], v[204:207], v[76:79], v[176:191]
    ds_read_b64_tr_b16 v[196:197], v228 offset:2048
    ds_read_b64_tr_b16 v[198:199], v228 offset:2560
    v_exp_f32_e64 v211, v211 clamp
    v_exp_f32_e64 v212, v212 clamp
    v_exp_f32_e64 v213, v213 clamp
    v_exp_f32_e64 v214, v214 clamp
    s_waitcnt lgkmcnt(4)
    v_mfma_f32_32x32x16_bf16 v[160:175], v[0:3], v[80:83], v[160:175]
    ds_read_b64_tr_b16 v[200:201], v227 offset:4096
    ds_read_b64_tr_b16 v[202:203], v227 offset:4608
    v_exp_f32_e64 v215, v215 clamp
    v_max_f32 v144, s33, v144
    v_max_f32 v145, s33, v145
    v_max_f32 v146, s33, v146
    v_max_f32 v147, s33, v147
    v_max_f32 v148, s33, v148
    v_mfma_f32_32x32x16_bf16 v[176:191], v[4:7], v[80:83], v[176:191]
    ds_read_b64_tr_b16 v[204:205], v228 offset:4096
    ds_read_b64_tr_b16 v[206:207], v228 offset:4608
    v_max_f32 v149, s33, v149
    v_max_f32 v150, s33, v150
    v_max_f32 v151, s33, v151
    v_add_f32 v144, v144, v208
    v_add_f32 v145, v145, v209
    v_add_f32 v146, v146, v210
    v_add_f32 v147, v147, v211
    s_waitcnt lgkmcnt(4)
    v_mfma_f32_32x32x16_bf16 v[160:175], v[192:195], v[84:87], v[160:175]
    ds_read_b64_tr_b16 v[0:1], v227 offset:6144
    ds_read_b64_tr_b16 v[2:3], v227 offset:6656
    v_add_f32 v148, v148, v212
    v_add_f32 v149, v149, v213
    v_add_f32 v150, v150, v214
    v_add_f32 v151, v151, v215
    v_cvt_pk_bf16_f32 v220, v144, v145
    v_cvt_pk_bf16_f32 v221, v146, v147
    v_cvt_pk_bf16_f32 v222, v148, v149
    v_mfma_f32_32x32x16_bf16 v[176:191], v[196:199], v[84:87], v[176:191]
    ds_read_b64_tr_b16 v[4:5], v228 offset:6144
    ds_read_b64_tr_b16 v[6:7], v228 offset:6656
    v_cvt_pk_bf16_f32 v223, v150, v151
    v_fma_f32 v152, v152, v234, v255
    v_fma_f32 v153, v153, v234, v255
    v_fma_f32 v154, v154, v234, v255
    v_fma_f32 v155, v155, v234, v255
    v_fma_f32 v156, v156, v234, v255
    v_fma_f32 v157, v157, v234, v255
    s_waitcnt lgkmcnt(4)
    v_mfma_f32_32x32x16_bf16 v[160:175], v[200:203], v[88:91], v[160:175]
    s_waitcnt lgkmcnt(0)
    s_waitcnt vmcnt(2)
    s_barrier
    ds_read_b64_tr_b16 v[192:193], v227 offset:16384
    ds_read_b64_tr_b16 v[194:195], v227 offset:16896
    v_fma_f32 v158, v158, v234, v255
    v_fma_f32 v159, v159, v234, v255
    v_fma_f32 v208, v152, s93, v254
    v_fma_f32 v209, v153, s93, v254
    v_fma_f32 v210, v154, s93, v254
    v_fma_f32 v211, v155, s93, v254
    v_fma_f32 v212, v156, s93, v254
    v_mfma_f32_32x32x16_bf16 v[176:191], v[204:207], v[88:91], v[176:191]
    ds_read_b64_tr_b16 v[196:197], v228 offset:16384
    ds_read_b64_tr_b16 v[198:199], v228 offset:16896
    v_fma_f32 v213, v157, s93, v254
    v_fma_f32 v214, v158, s93, v254
    v_fma_f32 v215, v159, s93, v254
    v_exp_f32_e64 v208, v208 clamp
    v_exp_f32_e64 v209, v209 clamp
    v_mfma_f32_32x32x16_bf16 v[160:175], v[0:3], v[92:95], v[160:175]
    ds_read_b64_tr_b16 v[200:201], v227 offset:18432
    ds_read_b64_tr_b16 v[202:203], v227 offset:18944
    v_exp_f32_e64 v210, v210 clamp
    v_exp_f32_e64 v211, v211 clamp
    v_exp_f32_e64 v212, v212 clamp
    v_exp_f32_e64 v213, v213 clamp
    v_mfma_f32_32x32x16_bf16 v[176:191], v[4:7], v[92:95], v[176:191]
    ds_read_b64_tr_b16 v[204:205], v228 offset:18432
    ds_read_b64_tr_b16 v[206:207], v228 offset:18944
    v_exp_f32_e64 v214, v214 clamp
    v_exp_f32_e64 v215, v215 clamp
    v_max_f32 v152, s33, v152
    v_max_f32 v153, s33, v153
    v_max_f32 v154, s33, v154
    s_waitcnt lgkmcnt(4)
    v_mfma_f32_32x32x16_bf16 v[160:175], v[192:195], v[96:99], v[160:175]
    ds_read_b64_tr_b16 v[0:1], v227 offset:20480
    ds_read_b64_tr_b16 v[2:3], v227 offset:20992
    v_max_f32 v155, s33, v155
    v_max_f32 v156, s33, v156
    v_max_f32 v157, s33, v157
    v_max_f32 v158, s33, v158
    v_max_f32 v159, s33, v159
    v_add_f32 v152, v152, v208
    v_add_f32 v153, v153, v209
    v_mfma_f32_32x32x16_bf16 v[176:191], v[196:199], v[96:99], v[176:191]
    ds_read_b64_tr_b16 v[4:5], v228 offset:20480
    ds_read_b64_tr_b16 v[6:7], v228 offset:20992
    v_add_f32 v154, v154, v210
    v_add_f32 v155, v155, v211
    v_add_f32 v156, v156, v212
    v_add_f32 v157, v157, v213
    v_add_f32 v158, v158, v214
    v_add_f32 v159, v159, v215
    v_cvt_pk_bf16_f32 v148, v152, v153
    s_waitcnt lgkmcnt(4)
    v_mfma_f32_32x32x16_bf16 v[160:175], v[200:203], v[100:103], v[160:175]
    ds_read_b64_tr_b16 v[192:193], v227 offset:22528
    ds_read_b64_tr_b16 v[194:195], v227 offset:23040
    v_cvt_pk_bf16_f32 v149, v154, v155
    v_cvt_pk_bf16_f32 v150, v156, v157
    v_cvt_pk_bf16_f32 v151, v158, v159
    v_mov_b32 v144, v220
    v_mov_b32 v145, v221
    v_mov_b32 v146, v222
    v_mov_b32 v147, v223
    s_mul_i32 s29, s28, 1280
    s_mov_b32 s31, 2
    s_mul_i32 s31, s31, 112
    s_cmp_eq_u32 s31, 336
    s_cselect_b32 s30, 48, 64
    s_cmp_eq_u32 s28, 15
    s_cselect_b32 s30, s30, 0
    s_add_u32 s31, s31, s30
    s_add_u32 s29, s29, s31
    s_add_u32 s29, s29, 66048
    v_mfma_f32_32x32x16_bf16 v[176:191], v[204:207], v[100:103], v[176:191]
    ds_read_b64_tr_b16 v[196:197], v228 offset:22528
    ds_read_b64_tr_b16 v[198:199], v228 offset:23040
    v_and_b32 v247, 31, v226
    v_lshl_add_u32 v247, v247, 2, s29
    buffer_load_dword v231, v247, s[44:47], 0 offen sc1
    s_mul_i32 s29, s28, 1280
    s_mov_b32 s31, 3
    s_mul_i32 s31, s31, 112
    s_cmp_eq_u32 s31, 336
    s_cselect_b32 s30, 48, 64
    s_cmp_eq_u32 s28, 15
    s_cselect_b32 s30, s30, 0
    s_add_u32 s31, s31, s30
    s_add_u32 s29, s29, s31
    s_add_u32 s29, s29, 66048
    v_and_b32 v247, 31, v226
    v_lshl_add_u32 v247, v247, 2, s29
    buffer_load_dword v232, v247, s[44:47], 0 offen sc1
    s_waitcnt lgkmcnt(4)
    v_mfma_f32_32x32x16_bf16 v[160:175], v[0:3], v[104:107], v[160:175]
    v_mfma_f32_32x32x16_bf16 v[176:191], v[4:7], v[104:107], v[176:191]
    s_waitcnt lgkmcnt(0)
    v_mfma_f32_32x32x16_bf16 v[160:175], v[192:195], v[108:111], v[160:175]
    v_mfma_f32_32x32x16_bf16 v[176:191], v[196:199], v[108:111], v[176:191]
    s_setprio 0
    s_waitcnt lgkmcnt(0)
    s_barrier
    s_waitcnt vmcnt(0)
    v_cndmask_b32 v231, 0, v231, s[90:91]
    v_and_b32 v246, s3, v231
    v_sub_f32 v231, v231, v246
    v_and_b32 v247, s3, v231
    v_lshrrev_b32 v246, 16, v246
    v_sub_f32 v231, v231, v247
    v_or_b32 v242, v246, v247
    v_lshrrev_b32 v243, 16, v231
    s_nop 1
    v_mfma_f32_32x32x16_bf16 v[160:175], v[242:245], v[238:241], v[160:175]
    v_cndmask_b32 v232, 0, v232, s[90:91]
    v_and_b32 v246, s3, v232
    v_sub_f32 v232, v232, v246
    v_and_b32 v247, s3, v232
    v_lshrrev_b32 v246, 16, v246
    v_sub_f32 v232, v232, v247
    v_or_b32 v242, v246, v247
    v_lshrrev_b32 v243, 16, v232
    s_nop 1
    v_mfma_f32_32x32x16_bf16 v[176:191], v[242:245], v[238:241], v[176:191]
    v_mov_b32 v254, 3049366176
    v_mov_b32 v255, s33
    s_nop 12
    v_fma_f32 v160, v160, v234, v255
    v_fma_f32 v161, v161, v234, v255
    v_fma_f32 v162, v162, v234, v255
    v_fma_f32 v163, v163, v234, v255
    v_fma_f32 v164, v164, v234, v255
    v_fma_f32 v165, v165, v234, v255
    v_fma_f32 v166, v166, v234, v255
    v_fma_f32 v167, v167, v234, v255
    v_fma_f32 v208, v160, s93, v254
    v_fma_f32 v209, v161, s93, v254
    v_fma_f32 v210, v162, s93, v254
    v_fma_f32 v211, v163, s93, v254
    v_fma_f32 v212, v164, s93, v254
    v_fma_f32 v213, v165, s93, v254
    v_fma_f32 v214, v166, s93, v254
    v_fma_f32 v215, v167, s93, v254
    v_exp_f32_e64 v208, v208 clamp
    v_exp_f32_e64 v209, v209 clamp
    v_exp_f32_e64 v210, v210 clamp
    v_exp_f32_e64 v211, v211 clamp
    v_exp_f32_e64 v212, v212 clamp
    v_exp_f32_e64 v213, v213 clamp
    v_exp_f32_e64 v214, v214 clamp
    v_exp_f32_e64 v215, v215 clamp
    v_max_f32 v160, s33, v160
    v_max_f32 v161, s33, v161
    v_max_f32 v162, s33, v162
    v_max_f32 v163, s33, v163
    v_max_f32 v164, s33, v164
    v_max_f32 v165, s33, v165
    v_max_f32 v166, s33, v166
    v_max_f32 v167, s33, v167
    v_add_f32 v160, v160, v208
    v_add_f32 v161, v161, v209
    v_add_f32 v162, v162, v210
    v_add_f32 v163, v163, v211
    v_add_f32 v164, v164, v212
    v_add_f32 v165, v165, v213
    v_add_f32 v166, v166, v214
    v_add_f32 v167, v167, v215
    v_cvt_pk_bf16_f32 v220, v160, v161
    v_cvt_pk_bf16_f32 v221, v162, v163
    v_cvt_pk_bf16_f32 v222, v164, v165
    v_cvt_pk_bf16_f32 v223, v166, v167
    v_fma_f32 v168, v168, v234, v255
    v_fma_f32 v169, v169, v234, v255
    v_fma_f32 v170, v170, v234, v255
    v_fma_f32 v171, v171, v234, v255
    v_fma_f32 v172, v172, v234, v255
    v_fma_f32 v173, v173, v234, v255
    v_fma_f32 v174, v174, v234, v255
    v_fma_f32 v175, v175, v234, v255
    v_fma_f32 v208, v168, s93, v254
    v_fma_f32 v209, v169, s93, v254
    v_fma_f32 v210, v170, s93, v254
    v_fma_f32 v211, v171, s93, v254
    v_fma_f32 v212, v172, s93, v254
    v_fma_f32 v213, v173, s93, v254
    v_fma_f32 v214, v174, s93, v254
    v_fma_f32 v215, v175, s93, v254
    v_exp_f32_e64 v208, v208 clamp
    v_exp_f32_e64 v209, v209 clamp
    v_exp_f32_e64 v210, v210 clamp
    v_exp_f32_e64 v211, v211 clamp
    v_exp_f32_e64 v212, v212 clamp
    v_exp_f32_e64 v213, v213 clamp
    v_exp_f32_e64 v214, v214 clamp
    v_exp_f32_e64 v215, v215 clamp
    v_max_f32 v168, s33, v168
    v_max_f32 v169, s33, v169
    v_max_f32 v170, s33, v170
    v_max_f32 v171, s33, v171
    v_max_f32 v172, s33, v172
    v_max_f32 v173, s33, v173
    v_max_f32 v174, s33, v174
    v_max_f32 v175, s33, v175
    v_add_f32 v168, v168, v208
    v_add_f32 v169, v169, v209
    v_add_f32 v170, v170, v210
    v_add_f32 v171, v171, v211
    v_add_f32 v172, v172, v212
    v_add_f32 v173, v173, v213
    v_add_f32 v174, v174, v214
    v_add_f32 v175, v175, v215
    v_cvt_pk_bf16_f32 v164, v168, v169
    v_cvt_pk_bf16_f32 v165, v170, v171
    v_cvt_pk_bf16_f32 v166, v172, v173
    v_cvt_pk_bf16_f32 v167, v174, v175
    v_mov_b32 v160, v220
    v_mov_b32 v161, v221
    v_mov_b32 v162, v222
    v_mov_b32 v163, v223
    v_fma_f32 v176, v176, v234, v255
    v_fma_f32 v177, v177, v234, v255
    v_fma_f32 v178, v178, v234, v255
    v_fma_f32 v179, v179, v234, v255
    v_fma_f32 v180, v180, v234, v255
    v_fma_f32 v181, v181, v234, v255
    v_fma_f32 v182, v182, v234, v255
    v_fma_f32 v183, v183, v234, v255
    v_fma_f32 v208, v176, s93, v254
    v_fma_f32 v209, v177, s93, v254
    v_fma_f32 v210, v178, s93, v254
    v_fma_f32 v211, v179, s93, v254
    v_fma_f32 v212, v180, s93, v254
    v_fma_f32 v213, v181, s93, v254
    v_fma_f32 v214, v182, s93, v254
    v_fma_f32 v215, v183, s93, v254
    v_exp_f32_e64 v208, v208 clamp
    v_exp_f32_e64 v209, v209 clamp
    v_exp_f32_e64 v210, v210 clamp
    v_exp_f32_e64 v211, v211 clamp
    v_exp_f32_e64 v212, v212 clamp
    v_exp_f32_e64 v213, v213 clamp
    v_exp_f32_e64 v214, v214 clamp
    v_exp_f32_e64 v215, v215 clamp
    v_max_f32 v176, s33, v176
    v_max_f32 v177, s33, v177
    v_max_f32 v178, s33, v178
    v_max_f32 v179, s33, v179
    v_max_f32 v180, s33, v180
    v_max_f32 v181, s33, v181
    v_max_f32 v182, s33, v182
    v_max_f32 v183, s33, v183
    v_add_f32 v176, v176, v208
    v_add_f32 v177, v177, v209
    v_add_f32 v178, v178, v210
    v_add_f32 v179, v179, v211
    v_add_f32 v180, v180, v212
    v_add_f32 v181, v181, v213
    v_add_f32 v182, v182, v214
    v_add_f32 v183, v183, v215
    v_cvt_pk_bf16_f32 v220, v176, v177
    v_cvt_pk_bf16_f32 v221, v178, v179
    v_cvt_pk_bf16_f32 v222, v180, v181
    v_cvt_pk_bf16_f32 v223, v182, v183
    v_fma_f32 v184, v184, v234, v255
    v_fma_f32 v185, v185, v234, v255
    v_fma_f32 v186, v186, v234, v255
    v_fma_f32 v187, v187, v234, v255
    v_fma_f32 v188, v188, v234, v255
    v_fma_f32 v189, v189, v234, v255
    v_fma_f32 v190, v190, v234, v255
    v_fma_f32 v191, v191, v234, v255
    v_fma_f32 v208, v184, s93, v254
    v_fma_f32 v209, v185, s93, v254
    v_fma_f32 v210, v186, s93, v254
    v_fma_f32 v211, v187, s93, v254
    v_fma_f32 v212, v188, s93, v254
    v_fma_f32 v213, v189, s93, v254
    v_fma_f32 v214, v190, s93, v254
    v_fma_f32 v215, v191, s93, v254
    v_exp_f32_e64 v208, v208 clamp
    v_exp_f32_e64 v209, v209 clamp
    v_exp_f32_e64 v210, v210 clamp
    v_exp_f32_e64 v211, v211 clamp
    v_exp_f32_e64 v212, v212 clamp
    v_exp_f32_e64 v213, v213 clamp
    v_exp_f32_e64 v214, v214 clamp
    v_exp_f32_e64 v215, v215 clamp
    v_max_f32 v184, s33, v184
    v_max_f32 v185, s33, v185
    v_max_f32 v186, s33, v186
    v_max_f32 v187, s33, v187
    v_max_f32 v188, s33, v188
    v_max_f32 v189, s33, v189
    v_max_f32 v190, s33, v190
    v_max_f32 v191, s33, v191
    v_add_f32 v184, v184, v208
    v_add_f32 v185, v185, v209
    v_add_f32 v186, v186, v210
    v_add_f32 v187, v187, v211
    v_add_f32 v188, v188, v212
    v_add_f32 v189, v189, v213
    v_add_f32 v190, v190, v214
    v_add_f32 v191, v191, v215
    v_cvt_pk_bf16_f32 v180, v184, v185
    v_cvt_pk_bf16_f32 v181, v186, v187
    v_cvt_pk_bf16_f32 v182, v188, v189
    v_cvt_pk_bf16_f32 v183, v190, v191
    v_mov_b32 v176, v220
    v_mov_b32 v177, v221
    v_mov_b32 v178, v222
    v_mov_b32 v179, v223
    s_sub_u32 s29, s28, 14
    s_lshl_b32 s29, s29, 3
    s_add_u32 s29, s29, 0
    v_and_b32 v246, 7, v226
    v_add_u32 v246, s29, v246
    v_lshlrev_b32 v246, 7, v246
    v_add_u32 v246, 86016, v246
    s_cmp_lg_u32 s24, 0
    s_cbranch_scc1 L_kvpoll_36
    s_mov_b32 s31, 0
L_kvwait_37:
    buffer_load_dword v247, v246, s[44:47], 0 offen sc1
    s_add_u32 s31, s31, 1
    s_waitcnt vmcnt(0)
    v_cmp_gt_u32 vcc, 16, v247
    s_nop 4
    s_cmp_gt_u32 s31, 400000
    s_cbranch_scc1 L_kvwait_done_38
    s_cbranch_vccz L_kvwait_done_38
    s_sleep 1
    s_branch L_kvwait_37
L_kvwait_done_38:
L_kvpoll_36:
    s_barrier
    s_sub_u32 s29, s28, 14
    s_lshl_b32 s29, s29, 3
    s_add_u32 s29, s29, s24
    s_lshl_b32 s29, s29, 12
    s_add_u32 s29, s29, 0
    v_lshlrev_b32 v246, 2, v226
    v_add_u32 v246, s29, v246
    buffer_load_dword v0, v246, s[44:47], 0 offen offset:0 sc1
    buffer_load_dword v1, v246, s[44:47], 0 offen offset:256 sc1
    buffer_load_dword v2, v246, s[44:47], 0 offen offset:512 sc1
    buffer_load_dword v3, v246, s[44:47], 0 offen offset:768 sc1
    buffer_load_dword v4, v246, s[44:47], 0 offen offset:1024 sc1
    buffer_load_dword v5, v246, s[44:47], 0 offen offset:1280 sc1
    buffer_load_dword v6, v246, s[44:47], 0 offen offset:1536 sc1
    buffer_load_dword v7, v246, s[44:47], 0 offen offset:1792 sc1
    buffer_load_dword v8, v246, s[44:47], 0 offen offset:2048 sc1
    buffer_load_dword v9, v246, s[44:47], 0 offen offset:2304 sc1
    buffer_load_dword v10, v246, s[44:47], 0 offen offset:2560 sc1
    buffer_load_dword v11, v246, s[44:47], 0 offen offset:2816 sc1
    buffer_load_dword v12, v246, s[44:47], 0 offen offset:3072 sc1
    buffer_load_dword v13, v246, s[44:47], 0 offen offset:3328 sc1
    buffer_load_dword v14, v246, s[44:47], 0 offen offset:3584 sc1
    buffer_load_dword v15, v246, s[44:47], 0 offen offset:3840 sc1
    s_waitcnt vmcnt(0)
    v_cvt_pk_bf16_f32 v16, v0, v1
    v_cvt_pk_bf16_f32 v17, v2, v3
    v_cvt_pk_bf16_f32 v18, v4, v5
    v_cvt_pk_bf16_f32 v19, v6, v7
    v_cvt_pk_bf16_f32 v20, v8, v9
    v_cvt_pk_bf16_f32 v21, v10, v11
    v_cvt_pk_bf16_f32 v22, v12, v13
    v_cvt_pk_bf16_f32 v23, v14, v15
    s_lshl_b32 s29, s24, 11
    s_add_u32 s29, s29, 147456
    v_lshlrev_b32 v246, 4, v226
    v_add_u32 v246, s29, v246
    ds_write_b128 v246, v[16:19]
    ds_write_b128 v246, v[20:23] offset:1024
    s_waitcnt lgkmcnt(0)
    s_barrier
    v_lshlrev_b32 v246, 4, v226
    v_add_u32 v246, 149504, v246
    ds_read_b128 v[0:3], v246
    ds_read_b128 v[4:7], v246 offset:1024
    s_waitcnt lgkmcnt(0)
    v_mfma_f32_32x32x16_bf16 v[16:31], v[0:3], v[112:115], 0
    v_mfma_f32_32x32x16_bf16 v[16:31], v[4:7], v[116:119], v[16:31]
    s_nop 15
    v_lshlrev_b32 v246, 4, v226
    v_add_u32 v246, 151552, v246
    ds_read_b128 v[8:11], v246
    ds_read_b128 v[12:15], v246 offset:1024
    s_waitcnt lgkmcnt(0)
    v_mfma_f32_32x32x16_bf16 v[48:63], v[8:11], v[128:131], 0
    v_mfma_f32_32x32x16_bf16 v[48:63], v[12:15], v[132:135], v[48:63]
    v_mov_b32 v32, v28
    v_mov_b32 v33, v28
    s_nop 1
    v_permlane32_swap_b32 v32, v33
    s_nop 1
    v_add_f32 v33, 897988541, v33
    v_rcp_f32 v33, v33
    s_nop 0
    v_mul_f32 v16, v16, v33
    v_mul_f32 v17, v17, v33
    v_mul_f32 v18, v18, v33
    v_mul_f32 v19, v19, v33
    v_mul_f32 v20, v20, v33
    v_mul_f32 v21, v21, v33
    v_mul_f32 v22, v22, v33
    v_mul_f32 v23, v23, v33
    v_mul_f32 v24, v24, v33
    v_mul_f32 v25, v25, v33
    v_mul_f32 v26, v26, v33
    v_mul_f32 v27, v27, v33
    v_mul_f32 v28, v28, v33
    v_mul_f32 v29, v29, v33
    v_mul_f32 v30, v30, v33
    v_mul_f32 v31, v31, v33
    v_cvt_pk_bf16_f32 v36, v16, v17
    v_cvt_pk_bf16_f32 v37, v18, v19
    v_cvt_pk_bf16_f32 v38, v20, v21
    v_cvt_pk_bf16_f32 v39, v22, v23
    v_cvt_pk_bf16_f32 v40, v24, v25
    v_cvt_pk_bf16_f32 v41, v26, v27
    v_cvt_pk_bf16_f32 v42, v28, v29
    v_cvt_pk_bf16_f32 v43, v30, v31
    v_cmp_gt_u32 vcc, 32, v226
    v_mov_b32 v32, 0
    s_nop 1
    v_cndmask_b32 v42, v32, v42, vcc
    v_cndmask_b32 v43, v32, v43, vcc
    s_sub_u32 s30, s28, 14
    s_lshl_b32 s30, s30, 4
    s_add_u32 s30, s30, 114
    s_lshl_b32 s29, s27, 2
    s_add_u32 s29, s29, s26
    s_mul_i32 s29, s29, 144
    s_add_u32 s29, s29, s30
    s_lshl_b32 s29, s29, 10
    s_add_u32 s29, s29, 1048576
    v_lshlrev_b32 v246, 4, v226
    v_add_u32 v246, s29, v246
    buffer_store_dwordx4 v[36:39], v246, s[44:47], 0 offen sc1
    buffer_store_dwordx4 v[40:43], v246, s[44:47], 0 offen offset:1024 sc1
    s_nop 1
    v_lshlrev_b32 v246, 4, v226
    v_add_u32 v246, 153600, v246
    ds_read_b128 v[0:3], v246
    ds_read_b128 v[4:7], v246 offset:1024
    s_waitcnt lgkmcnt(0)
    v_mfma_f32_32x32x16_bf16 v[16:31], v[0:3], v[144:147], 0
    v_mfma_f32_32x32x16_bf16 v[16:31], v[4:7], v[148:151], v[16:31]
    v_mov_b32 v32, v60
    v_mov_b32 v33, v60
    s_nop 1
    v_permlane32_swap_b32 v32, v33
    s_nop 1
    v_add_f32 v33, 897988541, v33
    v_rcp_f32 v33, v33
    s_nop 0
    v_mul_f32 v48, v48, v33
    v_mul_f32 v49, v49, v33
    v_mul_f32 v50, v50, v33
    v_mul_f32 v51, v51, v33
    v_mul_f32 v52, v52, v33
    v_mul_f32 v53, v53, v33
    v_mul_f32 v54, v54, v33
    v_mul_f32 v55, v55, v33
    v_mul_f32 v56, v56, v33
    v_mul_f32 v57, v57, v33
    v_mul_f32 v58, v58, v33
    v_mul_f32 v59, v59, v33
    v_mul_f32 v60, v60, v33
    v_mul_f32 v61, v61, v33
    v_mul_f32 v62, v62, v33
    v_mul_f32 v63, v63, v33
    v_cvt_pk_bf16_f32 v36, v48, v49
    v_cvt_pk_bf16_f32 v37, v50, v51
    v_cvt_pk_bf16_f32 v38, v52, v53
    v_cvt_pk_bf16_f32 v39, v54, v55
    v_cvt_pk_bf16_f32 v40, v56, v57
    v_cvt_pk_bf16_f32 v41, v58, v59
    v_cvt_pk_bf16_f32 v42, v60, v61
    v_cvt_pk_bf16_f32 v43, v62, v63
    v_cmp_gt_u32 vcc, 32, v226
    v_mov_b32 v32, 0
    s_nop 1
    v_cndmask_b32 v42, v32, v42, vcc
    v_cndmask_b32 v43, v32, v43, vcc
    s_sub_u32 s30, s28, 14
    s_lshl_b32 s30, s30, 4
    s_add_u32 s30, s30, 116
    s_lshl_b32 s29, s27, 2
    s_add_u32 s29, s29, s26
    s_mul_i32 s29, s29, 144
    s_add_u32 s29, s29, s30
    s_lshl_b32 s29, s29, 10
    s_add_u32 s29, s29, 1048576
    v_lshlrev_b32 v246, 4, v226
    v_add_u32 v246, s29, v246
    buffer_store_dwordx4 v[36:39], v246, s[44:47], 0 offen sc1
    buffer_store_dwordx4 v[40:43], v246, s[44:47], 0 offen offset:1024 sc1
    s_nop 1
    v_lshlrev_b32 v246, 4, v226
    v_add_u32 v246, 159744, v246
    ds_read_b128 v[8:11], v246
    ds_read_b128 v[12:15], v246 offset:1024
    s_waitcnt lgkmcnt(0)
    v_mfma_f32_32x32x16_bf16 v[48:63], v[8:11], v[160:163], 0
    v_mfma_f32_32x32x16_bf16 v[48:63], v[12:15], v[164:167], v[48:63]
    v_mov_b32 v32, v28
    v_mov_b32 v33, v28
    s_nop 1
    v_permlane32_swap_b32 v32, v33
    s_nop 1
    v_add_f32 v33, 897988541, v33
    v_rcp_f32 v33, v33
    s_nop 0
    v_mul_f32 v16, v16, v33
    v_mul_f32 v17, v17, v33
    v_mul_f32 v18, v18, v33
    v_mul_f32 v19, v19, v33
    v_mul_f32 v20, v20, v33
    v_mul_f32 v21, v21, v33
    v_mul_f32 v22, v22, v33
    v_mul_f32 v23, v23, v33
    v_mul_f32 v24, v24, v33
    v_mul_f32 v25, v25, v33
    v_mul_f32 v26, v26, v33
    v_mul_f32 v27, v27, v33
    v_mul_f32 v28, v28, v33
    v_mul_f32 v29, v29, v33
    v_mul_f32 v30, v30, v33
    v_mul_f32 v31, v31, v33
    v_cvt_pk_bf16_f32 v36, v16, v17
    v_cvt_pk_bf16_f32 v37, v18, v19
    v_cvt_pk_bf16_f32 v38, v20, v21
    v_cvt_pk_bf16_f32 v39, v22, v23
    v_cvt_pk_bf16_f32 v40, v24, v25
    v_cvt_pk_bf16_f32 v41, v26, v27
    v_cvt_pk_bf16_f32 v42, v28, v29
    v_cvt_pk_bf16_f32 v43, v30, v31
    v_cmp_gt_u32 vcc, 32, v226
    v_mov_b32 v32, 0
    s_nop 1
    v_cndmask_b32 v42, v32, v42, vcc
    v_cndmask_b32 v43, v32, v43, vcc
    s_sub_u32 s30, s28, 14
    s_lshl_b32 s30, s30, 4
    s_add_u32 s30, s30, 118
    s_lshl_b32 s29, s27, 2
    s_add_u32 s29, s29, s26
    s_mul_i32 s29, s29, 144
    s_add_u32 s29, s29, s30
    s_lshl_b32 s29, s29, 10
    s_add_u32 s29, s29, 1048576
    v_lshlrev_b32 v246, 4, v226
    v_add_u32 v246, s29, v246
    buffer_store_dwordx4 v[36:39], v246, s[44:47], 0 offen sc1
    buffer_store_dwordx4 v[40:43], v246, s[44:47], 0 offen offset:1024 sc1
    s_nop 1
    v_lshlrev_b32 v246, 4, v226
    v_add_u32 v246, 161792, v246
    ds_read_b128 v[0:3], v246
    ds_read_b128 v[4:7], v246 offset:1024
    s_waitcnt lgkmcnt(0)
    v_mfma_f32_32x32x16_bf16 v[16:31], v[0:3], v[176:179], 0
    v_mfma_f32_32x32x16_bf16 v[16:31], v[4:7], v[180:183], v[16:31]
    v_mov_b32 v32, v60
    v_mov_b32 v33, v60
    s_nop 1
    v_permlane32_swap_b32 v32, v33
    s_nop 1
    v_add_f32 v33, 897988541, v33
    v_rcp_f32 v33, v33
    s_nop 0
    v_mul_f32 v48, v48, v33
    v_mul_f32 v49, v49, v33
    v_mul_f32 v50, v50, v33
    v_mul_f32 v51, v51, v33
    v_mul_f32 v52, v52, v33
    v_mul_f32 v53, v53, v33
    v_mul_f32 v54, v54, v33
    v_mul_f32 v55, v55, v33
    v_mul_f32 v56, v56, v33
    v_mul_f32 v57, v57, v33
    v_mul_f32 v58, v58, v33
    v_mul_f32 v59, v59, v33
    v_mul_f32 v60, v60, v33
    v_mul_f32 v61, v61, v33
    v_mul_f32 v62, v62, v33
    v_mul_f32 v63, v63, v33
    v_cvt_pk_bf16_f32 v36, v48, v49
    v_cvt_pk_bf16_f32 v37, v50, v51
    v_cvt_pk_bf16_f32 v38, v52, v53
    v_cvt_pk_bf16_f32 v39, v54, v55
    v_cvt_pk_bf16_f32 v40, v56, v57
    v_cvt_pk_bf16_f32 v41, v58, v59
    v_cvt_pk_bf16_f32 v42, v60, v61
    v_cvt_pk_bf16_f32 v43, v62, v63
    v_cmp_gt_u32 vcc, 32, v226
    v_mov_b32 v32, 0
    s_nop 1
    v_cndmask_b32 v42, v32, v42, vcc
    v_cndmask_b32 v43, v32, v43, vcc
    s_sub_u32 s30, s28, 14
    s_lshl_b32 s30, s30, 4
    s_add_u32 s30, s30, 124
    s_lshl_b32 s29, s27, 2
    s_add_u32 s29, s29, s26
    s_mul_i32 s29, s29, 144
    s_add_u32 s29, s29, s30
    s_lshl_b32 s29, s29, 10
    s_add_u32 s29, s29, 1048576
    v_lshlrev_b32 v246, 4, v226
    v_add_u32 v246, s29, v246
    buffer_store_dwordx4 v[36:39], v246, s[44:47], 0 offen sc1
    buffer_store_dwordx4 v[40:43], v246, s[44:47], 0 offen offset:1024 sc1
    s_nop 1
    s_nop 7
    v_mov_b32 v32, v28
    v_mov_b32 v33, v28
    v_mov_b32 v34, v16
    v_mov_b32 v35, v16
    s_nop 1
    v_permlane32_swap_b32 v32, v33
    v_permlane32_swap_b32 v34, v35
    s_cmp_eq_u32 s28, 15
    s_cselect_b64 s[30:31], -1, 0
    s_nop 1
    v_cndmask_b32 v33, v33, v34, s[30:31]
    s_nop 1
    v_add_f32 v33, 897988541, v33
    v_rcp_f32 v33, v33
    s_nop 0
    v_mul_f32 v16, v16, v33
    v_mul_f32 v17, v17, v33
    v_mul_f32 v18, v18, v33
    v_mul_f32 v19, v19, v33
    v_mul_f32 v20, v20, v33
    v_mul_f32 v21, v21, v33
    v_mul_f32 v22, v22, v33
    v_mul_f32 v23, v23, v33
    v_mul_f32 v24, v24, v33
    v_mul_f32 v25, v25, v33
    v_mul_f32 v26, v26, v33
    v_mul_f32 v27, v27, v33
    v_mul_f32 v28, v28, v33
    v_mul_f32 v29, v29, v33
    v_mul_f32 v30, v30, v33
    v_mul_f32 v31, v31, v33
    v_cvt_pk_bf16_f32 v36, v16, v17
    v_cvt_pk_bf16_f32 v37, v18, v19
    v_cvt_pk_bf16_f32 v38, v20, v21
    v_cvt_pk_bf16_f32 v39, v22, v23
    v_cvt_pk_bf16_f32 v40, v24, v25
    v_cvt_pk_bf16_f32 v41, v26, v27
    v_cvt_pk_bf16_f32 v42, v28, v29
    v_cvt_pk_bf16_f32 v43, v30, v31
    v_cmp_gt_u32 vcc, 32, v226
    v_mov_b32 v32, 0
    s_cmp_eq_u32 s28, 15
    s_cbranch_scc1 L_o15_39
    s_nop 1
    v_cndmask_b32 v42, v32, v42, vcc
    v_cndmask_b32 v43, v32, v43, vcc
    s_branch L_o15d_40
L_o15_39:
    s_nop 1
    v_cndmask_b32 v36, v36, v32, vcc
    v_cndmask_b32 v37, v37, v32, vcc
L_o15d_40:
    s_sub_u32 s30, s28, 14
    s_lshl_b32 s30, s30, 4
    s_add_u32 s30, s30, 126
    s_lshl_b32 s29, s27, 2
    s_add_u32 s29, s29, s26
    s_mul_i32 s29, s29, 144
    s_add_u32 s29, s29, s30
    s_lshl_b32 s29, s29, 10
    s_add_u32 s29, s29, 1048576
    v_lshlrev_b32 v246, 4, v226
    v_add_u32 v246, s29, v246
    buffer_store_dwordx4 v[36:39], v246, s[44:47], 0 offen sc1
    buffer_store_dwordx4 v[40:43], v246, s[44:47], 0 offen offset:1024 sc1
    s_nop 1
    s_waitcnt vmcnt(0)
    s_barrier
    s_cmp_lg_u32 s24, 0
    s_cbranch_scc1 L_osig_41
    s_add_u32 s29, s27, 32
    s_lshl_b32 s29, s29, 7
    s_add_u32 s29, s29, 86016
    v_mov_b32 v246, s29
    v_mov_b32 v247, 1
    v_cmp_eq_u32 vcc, 0, v226
    s_and_saveexec_b64 s[30:31], vcc
    buffer_atomic_add v247, v246, s[44:47], 0 offen
    s_mov_b64 exec, s[30:31]
L_osig_41:
    s_waitcnt vmcnt(0)
    s_endpgm
L_g2_20:
    ds_read_b64_tr_b16 v[32:33], v232 offset:0
    ds_read_b64_tr_b16 v[34:35], v232 offset:1024
    ds_read_b64_tr_b16 v[36:37], v233 offset:0
    ds_read_b64_tr_b16 v[38:39], v233 offset:1024
    ds_read_b64_tr_b16 v[40:41], v232 offset:2048
    ds_read_b64_tr_b16 v[42:43], v232 offset:3072
    ds_read_b64_tr_b16 v[44:45], v233 offset:2048
    ds_read_b64_tr_b16 v[46:47], v233 offset:3072
    ds_read_b64_tr_b16 v[48:49], v232 offset:4096
    ds_read_b64_tr_b16 v[50:51], v232 offset:5120
    ds_read_b64_tr_b16 v[52:53], v233 offset:4096
    ds_read_b64_tr_b16 v[54:55], v233 offset:5120
    ds_read_b64_tr_b16 v[56:57], v232 offset:6144
    ds_read_b64_tr_b16 v[58:59], v232 offset:7168
    ds_read_b64_tr_b16 v[60:61], v233 offset:6144
    ds_read_b64_tr_b16 v[62:63], v233 offset:7168
    s_waitcnt lgkmcnt(12)
    ds_read_b64_tr_b16 v[64:65], v232 offset:8192
    ds_read_b64_tr_b16 v[66:67], v232 offset:9216
    ds_read_b64_tr_b16 v[68:69], v233 offset:8192
    ds_read_b64_tr_b16 v[70:71], v233 offset:9216
    s_waitcnt lgkmcnt(12)
    ds_read_b64_tr_b16 v[72:73], v232 offset:10240
    ds_read_b64_tr_b16 v[74:75], v232 offset:11264
    ds_read_b64_tr_b16 v[76:77], v233 offset:10240
    ds_read_b64_tr_b16 v[78:79], v233 offset:11264
    s_waitcnt lgkmcnt(12)
    ds_read_b64_tr_b16 v[80:81], v232 offset:12288
    ds_read_b64_tr_b16 v[82:83], v232 offset:13312
    ds_read_b64_tr_b16 v[84:85], v233 offset:12288
    ds_read_b64_tr_b16 v[86:87], v233 offset:13312
    s_waitcnt lgkmcnt(12)
    ds_read_b64_tr_b16 v[88:89], v232 offset:14336
    ds_read_b64_tr_b16 v[90:91], v232 offset:15360
    ds_read_b64_tr_b16 v[92:93], v233 offset:14336
    ds_read_b64_tr_b16 v[94:95], v233 offset:15360
    s_waitcnt lgkmcnt(12)
    ds_read_b64_tr_b16 v[96:97], v232 offset:16384
    ds_read_b64_tr_b16 v[98:99], v232 offset:17408
    ds_read_b64_tr_b16 v[100:101], v233 offset:16384
    ds_read_b64_tr_b16 v[102:103], v233 offset:17408
    s_waitcnt lgkmcnt(12)
    ds_read_b64_tr_b16 v[104:105], v232 offset:18432
    ds_read_b64_tr_b16 v[106:107], v232 offset:19456
    ds_read_b64_tr_b16 v[108:109], v233 offset:18432
    ds_read_b64_tr_b16 v[110:111], v233 offset:19456
    s_waitcnt lgkmcnt(12)
    s_add_u32 s29, s35, 200704
    s_cmp_eq_u32 s26, 3
    s_cselect_b32 s38, s29, s38
    s_lshl_b32 s29, s24, 2
    s_add_u32 s29, s29, 155648
    v_mov_b32 v240, s29
    v_mov_b32 v241, 0
    v_mov_b32 v242, 155680
    ds_write_b32 v240, v241
    ds_write_b32 v242, v241
    s_waitcnt lgkmcnt(0)
    s_barrier
    s_cmp_eq_u32 s26, 3
    s_cbranch_scc1 L_g2_s_42
    s_mov_b32 m0, s37
    s_nop 0
    buffer_load_dwordx4 v237, s[12:15], s38 offen lds
    s_add_u32 m0, m0, 2048
    s_cmp_eq_u32 s73, 20
    s_cselect_b32 s29, s74, 14336
    s_add_u32 s38, s38, s29
    buffer_load_dwordx4 v237, s[12:15], s38 offen lds
    s_add_u32 m0, m0, 2048
    s_cmp_eq_u32 s73, 21
    s_cselect_b32 s29, s74, 14336
    s_add_u32 s38, s38, s29
    buffer_load_dwordx4 v237, s[12:15], s38 offen lds
    s_add_u32 m0, m0, 2048
    s_cmp_eq_u32 s73, 22
    s_cselect_b32 s29, s74, 14336
    s_add_u32 s38, s38, s29
    buffer_load_dwordx4 v237, s[12:15], s38 offen lds
    s_add_u32 m0, m0, 2048
    s_cmp_eq_u32 s73, 23
    s_cselect_b32 s29, s74, 14336
    s_add_u32 s38, s38, s29
    buffer_load_dwordx4 v237, s[12:15], s38 offen lds
    s_add_u32 m0, m0, 2048
    s_cmp_eq_u32 s73, 24
    s_cselect_b32 s29, s74, 14336
    s_add_u32 s38, s38, s29
    buffer_load_dwordx4 v237, s[12:15], s38 offen lds
    s_add_u32 m0, m0, 2048
    s_cmp_eq_u32 s73, 25
    s_cselect_b32 s29, s74, 14336
    s_add_u32 s38, s38, s29
    buffer_load_dwordx4 v237, s[12:15], s38 offen lds
    s_add_u32 m0, m0, 2048
    s_cmp_eq_u32 s73, 26
    s_cselect_b32 s29, s74, 14336
    s_add_u32 s38, s38, s29
    buffer_load_dwordx4 v237, s[12:15], s38 offen lds
    s_add_u32 m0, m0, 2048
    s_cmp_eq_u32 s73, 27
    s_cselect_b32 s29, s74, 14336
    s_add_u32 s38, s38, s29
    buffer_load_dwordx4 v237, s[12:15], s38 offen lds
    s_add_u32 m0, m0, 2048
    s_cmp_eq_u32 s73, 28
    s_cselect_b32 s29, s74, 14336
    s_add_u32 s38, s38, s29
    buffer_load_dwordx4 v237, s[12:15], s38 offen lds
    s_add_u32 m0, m0, 2048
    s_cmp_eq_u32 s73, 29
    s_cselect_b32 s29, s74, 14336
    s_add_u32 s38, s38, s29
    ds_read_b64_tr_b16 v[112:113], v232 offset:20480
    ds_read_b64_tr_b16 v[114:115], v232 offset:21504
    ds_read_b64_tr_b16 v[116:117], v233 offset:20480
    ds_read_b64_tr_b16 v[118:119], v233 offset:21504
    ds_read_b64_tr_b16 v[120:121], v232 offset:22528
    ds_read_b64_tr_b16 v[122:123], v232 offset:23552
    ds_read_b64_tr_b16 v[124:125], v233 offset:22528
    ds_read_b64_tr_b16 v[126:127], v233 offset:23552
    ds_read_b64_tr_b16 v[128:129], v232 offset:24576
    ds_read_b64_tr_b16 v[130:131], v232 offset:25600
    ds_read_b64_tr_b16 v[132:133], v233 offset:24576
    ds_read_b64_tr_b16 v[134:135], v233 offset:25600
    ds_read_b64_tr_b16 v[136:137], v232 offset:26624
    ds_read_b64_tr_b16 v[138:139], v232 offset:27648
    ds_read_b64_tr_b16 v[140:141], v233 offset:26624
    ds_read_b64_tr_b16 v[142:143], v233 offset:27648
    s_waitcnt lgkmcnt(12)
    ds_read_b64_tr_b16 v[144:145], v232 offset:28672
    ds_read_b64_tr_b16 v[146:147], v232 offset:29696
    ds_read_b64_tr_b16 v[148:149], v233 offset:28672
    ds_read_b64_tr_b16 v[150:151], v233 offset:29696
    s_waitcnt lgkmcnt(12)
    ds_read_b64_tr_b16 v[152:153], v232 offset:30720
    ds_read_b64_tr_b16 v[154:155], v232 offset:31744
    ds_read_b64_tr_b16 v[156:157], v233 offset:30720
    ds_read_b64_tr_b16 v[158:159], v233 offset:31744
    s_waitcnt lgkmcnt(12)
    ds_read_b64_tr_b16 v[160:161], v232 offset:32768
    ds_read_b64_tr_b16 v[162:163], v232 offset:33792
    ds_read_b64_tr_b16 v[164:165], v233 offset:32768
    ds_read_b64_tr_b16 v[166:167], v233 offset:33792
    s_waitcnt lgkmcnt(12)
    ds_read_b64_tr_b16 v[168:169], v232 offset:34816
    ds_read_b64_tr_b16 v[170:171], v232 offset:35840
    ds_read_b64_tr_b16 v[172:173], v233 offset:34816
    ds_read_b64_tr_b16 v[174:175], v233 offset:35840
    s_waitcnt lgkmcnt(12)
    ds_read_b64_tr_b16 v[176:177], v232 offset:36864
    ds_read_b64_tr_b16 v[178:179], v232 offset:37888
    ds_read_b64_tr_b16 v[180:181], v233 offset:36864
    ds_read_b64_tr_b16 v[182:183], v233 offset:37888
    s_waitcnt lgkmcnt(12)
    s_waitcnt lgkmcnt(0)
    s_barrier
    buffer_load_dwordx4 v237, s[12:15], s38 offen lds
    s_add_u32 m0, m0, 2048
    s_cmp_eq_u32 s73, 30
    s_cselect_b32 s29, s74, 14336
    s_add_u32 s38, s38, s29
    buffer_load_dwordx4 v237, s[12:15], s38 offen lds
    s_add_u32 m0, m0, 2048
    s_cmp_eq_u32 s73, 31
    s_cselect_b32 s29, s74, 14336
    s_add_u32 s38, s38, s29
    buffer_load_dwordx4 v237, s[12:15], s38 offen lds
    s_add_u32 m0, m0, 2048
    s_cmp_eq_u32 s73, 32
    s_cselect_b32 s29, s74, 14336
    s_add_u32 s38, s38, s29
    buffer_load_dwordx4 v237, s[12:15], s38 offen lds
    s_add_u32 m0, m0, 2048
    s_cmp_eq_u32 s73, 33
    s_cselect_b32 s29, s74, 14336
    s_add_u32 s38, s38, s29
    buffer_load_dwordx4 v237, s[12:15], s38 offen lds
    s_add_u32 m0, m0, 2048
    s_cmp_eq_u32 s73, 34
    s_cselect_b32 s29, s74, 14336
    s_add_u32 s38, s38, s29
    buffer_load_dwordx4 v237, s[12:15], s38 offen lds
    s_add_u32 m0, m0, 2048
    s_cmp_eq_u32 s73, 35
    s_cselect_b32 s29, s74, 14336
    s_add_u32 s38, s38, s29
    buffer_load_dwordx4 v237, s[12:15], s38 offen lds
    s_add_u32 m0, m0, 2048
    s_cmp_eq_u32 s73, 36
    s_cselect_b32 s29, s74, 14336
    s_add_u32 s38, s38, s29
    s_cmp_eq_u32 s26, 2
    s_cselect_b32 s29, 0x40000000, 0
    s_add_u32 s38, s38, s29
    buffer_load_dwordx4 v237, s[12:15], s38 offen lds
    s_add_u32 m0, m0, 2048
    s_cmp_eq_u32 s73, 37
    s_cselect_b32 s29, s74, 14336
    s_add_u32 s38, s38, s29
    buffer_load_dwordx4 v237, s[12:15], s38 offen lds
    s_add_u32 m0, m0, 2048
    s_cmp_eq_u32 s73, 38
    s_cselect_b32 s29, s74, 14336
    s_add_u32 s38, s38, s29
    buffer_load_dwordx2 v[228:229], v235, s[20:23], 0 offen
    buffer_load_dwordx2 v[230:231], v235, s[20:23], 0 offen offset:16
    v_mov_b32 v240, 155680
    s_mov_b32 s31, 0
L_hl_44:
    ds_read_b32 v242, v240
    s_add_u32 s31, s31, 1
    s_waitcnt lgkmcnt(0)
    v_cmp_eq_u32 vcc, 0, v242
    s_cmp_gt_u32 s31, 3200000
    s_cbranch_scc1 L_hd_45
    s_nop 2
    s_cbranch_vccz L_hd_45
    s_sleep 1
    s_branch L_hl_44
L_hd_45:
    buffer_load_dwordx4 v[184:187], v234, s[44:47], s76 offen sc1
    s_add_u32 s76, s76, 1024
    buffer_load_dwordx4 v[188:191], v234, s[44:47], s76 offen sc1
    s_add_u32 s76, s76, 1024
    buffer_load_dwordx4 v[192:195], v234, s[44:47], s76 offen sc1
    s_add_u32 s76, s76, 1024
    buffer_load_dwordx4 v[196:199], v234, s[44:47], s76 offen sc1
    s_add_u32 s76, s76, 1024
    buffer_load_dwordx4 v[200:203], v234, s[44:47], s76 offen sc1
    s_add_u32 s76, s76, 1024
    buffer_load_dwordx4 v[204:207], v234, s[44:47], s76 offen sc1
    s_add_u32 s76, s76, 1024
    buffer_load_dwordx4 v[208:211], v234, s[44:47], s76 offen sc1
    s_add_u32 s76, s76, 1024
    buffer_load_dwordx4 v[212:215], v234, s[44:47], s76 offen sc1
    s_add_u32 s76, s76, 1024
    buffer_load_dwordx4 v[216:219], v234, s[44:47], s76 offen sc1
    s_add_u32 s76, s76, 1024
    buffer_load_dwordx4 v[220:223], v234, s[44:47], s76 offen sc1
    s_add_u32 s76, s76, 1024
    s_waitcnt vmcnt(9)
    v_mfma_f32_32x32x16_bf16 v[0:15], v[32:35], v[184:187], 0
    v_mfma_f32_32x32x16_bf16 v[16:31], v[36:39], v[184:187], 0
    buffer_load_dwordx4 v[184:187], v234, s[44:47], s76 offen sc1
    s_add_u32 s76, s76, 1024
    s_waitcnt vmcnt(9)
    v_mfma_f32_32x32x16_bf16 v[0:15], v[40:43], v[188:191], v[0:15]
    v_mfma_f32_32x32x16_bf16 v[16:31], v[44:47], v[188:191], v[16:31]
    buffer_load_dwordx4 v[188:191], v234, s[44:47], s76 offen sc1
    s_cmp_eq_u32 s73, 12
    s_cselect_b32 s29, s75, 1024
    s_add_u32 s76, s76, s29
    s_waitcnt vmcnt(9)
    v_mfma_f32_32x32x16_bf16 v[0:15], v[48:51], v[192:195], v[0:15]
    v_mfma_f32_32x32x16_bf16 v[16:31], v[52:55], v[192:195], v[16:31]
    buffer_load_dwordx4 v[192:195], v234, s[44:47], s76 offen sc1
    s_cmp_eq_u32 s73, 13
    s_cselect_b32 s29, s75, 1024
    s_add_u32 s76, s76, s29
    s_waitcnt vmcnt(9)
    v_mfma_f32_32x32x16_bf16 v[0:15], v[56:59], v[196:199], v[0:15]
    v_mfma_f32_32x32x16_bf16 v[16:31], v[60:63], v[196:199], v[16:31]
    buffer_load_dwordx4 v[196:199], v234, s[44:47], s76 offen sc1
    s_cmp_eq_u32 s73, 14
    s_cselect_b32 s29, s75, 1024
    s_add_u32 s76, s76, s29
    s_waitcnt vmcnt(9)
    v_mfma_f32_32x32x16_bf16 v[0:15], v[64:67], v[200:203], v[0:15]
    v_mfma_f32_32x32x16_bf16 v[16:31], v[68:71], v[200:203], v[16:31]
    buffer_load_dwordx4 v[200:203], v234, s[44:47], s76 offen sc1
    s_cmp_eq_u32 s73, 15
    s_cselect_b32 s29, s75, 1024
    s_add_u32 s76, s76, s29
    s_waitcnt vmcnt(9)
    v_mfma_f32_32x32x16_bf16 v[0:15], v[72:75], v[204:207], v[0:15]
    v_mfma_f32_32x32x16_bf16 v[16:31], v[76:79], v[204:207], v[16:31]
    buffer_load_dwordx4 v[204:207], v234, s[44:47], s76 offen sc1
    s_cmp_eq_u32 s73, 16
    s_cselect_b32 s29, s75, 1024
    s_add_u32 s76, s76, s29
    s_waitcnt vmcnt(9)
    v_mfma_f32_32x32x16_bf16 v[0:15], v[80:83], v[208:211], v[0:15]
    v_mfma_f32_32x32x16_bf16 v[16:31], v[84:87], v[208:211], v[16:31]
    buffer_load_dwordx4 v[208:211], v234, s[44:47], s76 offen sc1
    s_cmp_eq_u32 s73, 17
    s_cselect_b32 s29, s75, 1024
    s_add_u32 s76, s76, s29
    s_waitcnt vmcnt(9)
    v_mfma_f32_32x32x16_bf16 v[0:15], v[88:91], v[212:215], v[0:15]
    v_mfma_f32_32x32x16_bf16 v[16:31], v[92:95], v[212:215], v[16:31]
    buffer_load_dwordx4 v[212:215], v234, s[44:47], s76 offen sc1
    s_cmp_eq_u32 s73, 18
    s_cselect_b32 s29, s75, 1024
    s_add_u32 s76, s76, s29
    s_waitcnt vmcnt(9)
    v_mfma_f32_32x32x16_bf16 v[0:15], v[96:99], v[216:219], v[0:15]
    v_mfma_f32_32x32x16_bf16 v[16:31], v[100:103], v[216:219], v[16:31]
    buffer_load_dwordx4 v[216:219], v234, s[44:47], s76 offen sc1
    s_cmp_eq_u32 s73, 19
    s_cselect_b32 s29, s75, 1024
    s_add_u32 s76, s76, s29
    s_waitcnt vmcnt(9)
    v_mfma_f32_32x32x16_bf16 v[0:15], v[104:107], v[220:223], v[0:15]
    v_mfma_f32_32x32x16_bf16 v[16:31], v[108:111], v[220:223], v[16:31]
    buffer_load_dwordx4 v[220:223], v234, s[44:47], s76 offen sc1
    s_cmp_eq_u32 s73, 20
    s_cselect_b32 s29, s75, 1024
    s_add_u32 s76, s76, s29
    s_waitcnt vmcnt(9)
    v_mfma_f32_32x32x16_bf16 v[0:15], v[112:115], v[184:187], v[0:15]
    v_mfma_f32_32x32x16_bf16 v[16:31], v[116:119], v[184:187], v[16:31]
    buffer_load_dwordx4 v[184:187], v234, s[44:47], s76 offen sc1
    s_cmp_eq_u32 s73, 21
    s_cselect_b32 s29, s75, 1024
    s_add_u32 s76, s76, s29
    s_waitcnt vmcnt(9)
    v_mfma_f32_32x32x16_bf16 v[0:15], v[120:123], v[188:191], v[0:15]
    v_mfma_f32_32x32x16_bf16 v[16:31], v[124:127], v[188:191], v[16:31]
    buffer_load_dwordx4 v[188:191], v234, s[44:47], s76 offen sc1
    s_cmp_eq_u32 s73, 22
    s_cselect_b32 s29, s75, 1024
    s_add_u32 s76, s76, s29
    s_waitcnt vmcnt(9)
    v_mfma_f32_32x32x16_bf16 v[0:15], v[128:131], v[192:195], v[0:15]
    v_mfma_f32_32x32x16_bf16 v[16:31], v[132:135], v[192:195], v[16:31]
    buffer_load_dwordx4 v[192:195], v234, s[44:47], s76 offen sc1
    s_cmp_eq_u32 s73, 23
    s_cselect_b32 s29, s75, 1024
    s_add_u32 s76, s76, s29
    s_waitcnt vmcnt(9)
    v_mfma_f32_32x32x16_bf16 v[0:15], v[136:139], v[196:199], v[0:15]
    v_mfma_f32_32x32x16_bf16 v[16:31], v[140:143], v[196:199], v[16:31]
    buffer_load_dwordx4 v[196:199], v234, s[44:47], s76 offen sc1
    s_cmp_eq_u32 s73, 24
    s_cselect_b32 s29, s75, 1024
    s_add_u32 s76, s76, s29
    s_waitcnt vmcnt(9)
    v_mfma_f32_32x32x16_bf16 v[0:15], v[144:147], v[200:203], v[0:15]
    v_mfma_f32_32x32x16_bf16 v[16:31], v[148:151], v[200:203], v[16:31]
    buffer_load_dwordx4 v[200:203], v234, s[44:47], s76 offen sc1
    s_cmp_eq_u32 s73, 25
    s_cselect_b32 s29, s75, 1024
    s_add_u32 s76, s76, s29
    s_waitcnt vmcnt(9)
    v_mfma_f32_32x32x16_bf16 v[0:15], v[152:155], v[204:207], v[0:15]
    v_mfma_f32_32x32x16_bf16 v[16:31], v[156:159], v[204:207], v[16:31]
    buffer_load_dwordx4 v[204:207], v234, s[44:47], s76 offen sc1
    s_cmp_eq_u32 s73, 26
    s_cselect_b32 s29, s75, 1024
    s_add_u32 s76, s76, s29
    s_waitcnt vmcnt(9)
    v_mfma_f32_32x32x16_bf16 v[0:15], v[160:163], v[208:211], v[0:15]
    v_mfma_f32_32x32x16_bf16 v[16:31], v[164:167], v[208:211], v[16:31]
    buffer_load_dwordx4 v[208:211], v234, s[44:47], s76 offen sc1
    s_cmp_eq_u32 s73, 27
    s_cselect_b32 s29, s75, 1024
    s_add_u32 s76, s76, s29
    s_waitcnt vmcnt(9)
    v_mfma_f32_32x32x16_bf16 v[0:15], v[168:171], v[212:215], v[0:15]
    v_mfma_f32_32x32x16_bf16 v[16:31], v[172:175], v[212:215], v[16:31]
    buffer_load_dwordx4 v[212:215], v234, s[44:47], s76 offen sc1
    s_cmp_eq_u32 s73, 28
    s_cselect_b32 s29, s75, 1024
    s_add_u32 s76, s76, s29
    s_waitcnt vmcnt(9)
    v_mfma_f32_32x32x16_bf16 v[0:15], v[176:179], v[216:219], v[0:15]
    v_mfma_f32_32x32x16_bf16 v[16:31], v[180:183], v[216:219], v[16:31]
    buffer_load_dwordx4 v[216:219], v234, s[44:47], s76 offen sc1
    s_cmp_eq_u32 s73, 29
    s_cselect_b32 s29, s75, 1024
    s_add_u32 s76, s76, s29
    s_lshl_b32 s29, s24, 2
    s_add_u32 s29, s29, 155648
    v_mov_b32 v240, s29
    v_mov_b32 v241, 1
    ds_write_b32 v240, v241
    v_xor_b32 v240, 16, v240
    s_mov_b32 s31, 0
L_pair_46:
    ds_read_b32 v242, v240
    s_add_u32 s31, s31, 1
    s_waitcnt lgkmcnt(0)
    v_cmp_eq_u32 vcc, 0, v242
    s_cmp_gt_u32 s31, 3200000
    s_cbranch_scc1 L_pair_done_47
    s_nop 2
    s_cbranch_vccnz L_pair_46
L_pair_done_47:
    ds_read_b64_tr_b16 v[32:33], v232 offset:0
    ds_read_b64_tr_b16 v[34:35], v232 offset:1024
    ds_read_b64_tr_b16 v[36:37], v233 offset:0
    ds_read_b64_tr_b16 v[38:39], v233 offset:1024
    ds_read_b64_tr_b16 v[40:41], v232 offset:2048
    ds_read_b64_tr_b16 v[42:43], v232 offset:3072
    ds_read_b64_tr_b16 v[44:45], v233 offset:2048
    ds_read_b64_tr_b16 v[46:47], v233 offset:3072
    ds_read_b64_tr_b16 v[48:49], v232 offset:4096
    ds_read_b64_tr_b16 v[50:51], v232 offset:5120
    ds_read_b64_tr_b16 v[52:53], v233 offset:4096
    ds_read_b64_tr_b16 v[54:55], v233 offset:5120
    s_waitcnt lgkmcnt(8)
    s_waitcnt vmcnt(9)
    v_mfma_f32_32x32x16_bf16 v[0:15], v[32:35], v[220:223], v[0:15]
    v_mfma_f32_32x32x16_bf16 v[16:31], v[36:39], v[220:223], v[16:31]
    buffer_load_dwordx4 v[220:223], v234, s[44:47], s76 offen sc1
    s_cmp_eq_u32 s73, 30
    s_cselect_b32 s29, s75, 1024
    s_add_u32 s76, s76, s29
    ds_read_b64_tr_b16 v[32:33], v232 offset:6144
    ds_read_b64_tr_b16 v[34:35], v232 offset:7168
    ds_read_b64_tr_b16 v[36:37], v233 offset:6144
    ds_read_b64_tr_b16 v[38:39], v233 offset:7168
    s_waitcnt lgkmcnt(8)
    s_waitcnt vmcnt(9)
    v_mfma_f32_32x32x16_bf16 v[0:15], v[40:43], v[184:187], v[0:15]
    v_mfma_f32_32x32x16_bf16 v[16:31], v[44:47], v[184:187], v[16:31]
    buffer_load_dwordx4 v[184:187], v234, s[44:47], s76 offen sc1
    s_cmp_eq_u32 s73, 31
    s_cselect_b32 s29, s75, 1024
    s_add_u32 s76, s76, s29
    ds_read_b64_tr_b16 v[40:41], v232 offset:8192
    ds_read_b64_tr_b16 v[42:43], v232 offset:9216
    ds_read_b64_tr_b16 v[44:45], v233 offset:8192
    ds_read_b64_tr_b16 v[46:47], v233 offset:9216
    s_waitcnt lgkmcnt(8)
    s_waitcnt vmcnt(9)
    v_mfma_f32_32x32x16_bf16 v[0:15], v[48:51], v[188:191], v[0:15]
    v_mfma_f32_32x32x16_bf16 v[16:31], v[52:55], v[188:191], v[16:31]
    buffer_load_dwordx4 v[188:191], v234, s[44:47], s76 offen sc1
    s_cmp_eq_u32 s73, 32
    s_cselect_b32 s29, s75, 1024
    s_add_u32 s76, s76, s29
    ds_read_b64_tr_b16 v[48:49], v232 offset:10240
    ds_read_b64_tr_b16 v[50:51], v232 offset:11264
    ds_read_b64_tr_b16 v[52:53], v233 offset:10240
    ds_read_b64_tr_b16 v[54:55], v233 offset:11264
    s_waitcnt lgkmcnt(8)
    s_waitcnt vmcnt(9)
    v_mfma_f32_32x32x16_bf16 v[0:15], v[32:35], v[192:195], v[0:15]
    v_mfma_f32_32x32x16_bf16 v[16:31], v[36:39], v[192:195], v[16:31]
    buffer_load_dwordx4 v[192:195], v234, s[44:47], s76 offen sc1
    s_cmp_eq_u32 s73, 33
    s_cselect_b32 s29, s75, 1024
    s_add_u32 s76, s76, s29
    ds_read_b64_tr_b16 v[32:33], v232 offset:12288
    ds_read_b64_tr_b16 v[34:35], v232 offset:13312
    ds_read_b64_tr_b16 v[36:37], v233 offset:12288
    ds_read_b64_tr_b16 v[38:39], v233 offset:13312
    s_waitcnt lgkmcnt(8)
    s_waitcnt vmcnt(9)
    v_mfma_f32_32x32x16_bf16 v[0:15], v[40:43], v[196:199], v[0:15]
    v_mfma_f32_32x32x16_bf16 v[16:31], v[44:47], v[196:199], v[16:31]
    buffer_load_dwordx4 v[196:199], v234, s[44:47], s76 offen sc1
    s_cmp_eq_u32 s73, 34
    s_cselect_b32 s29, s75, 1024
    s_add_u32 s76, s76, s29
    ds_read_b64_tr_b16 v[40:41], v232 offset:14336
    ds_read_b64_tr_b16 v[42:43], v232 offset:15360
    ds_read_b64_tr_b16 v[44:45], v233 offset:14336
    ds_read_b64_tr_b16 v[46:47], v233 offset:15360
    s_waitcnt lgkmcnt(8)
    s_waitcnt vmcnt(9)
    v_mfma_f32_32x32x16_bf16 v[0:15], v[48:51], v[200:203], v[0:15]
    v_mfma_f32_32x32x16_bf16 v[16:31], v[52:55], v[200:203], v[16:31]
    buffer_load_dwordx4 v[200:203], v234, s[44:47], s76 offen sc1
    s_cmp_eq_u32 s73, 35
    s_cselect_b32 s29, s75, 1024
    s_add_u32 s76, s76, s29
    ds_read_b64_tr_b16 v[48:49], v232 offset:16384
    ds_read_b64_tr_b16 v[50:51], v232 offset:17408
    ds_read_b64_tr_b16 v[52:53], v233 offset:16384
    ds_read_b64_tr_b16 v[54:55], v233 offset:17408
    s_waitcnt lgkmcnt(8)
    s_waitcnt vmcnt(9)
    v_mfma_f32_32x32x16_bf16 v[0:15], v[32:35], v[204:207], v[0:15]
    v_mfma_f32_32x32x16_bf16 v[16:31], v[36:39], v[204:207], v[16:31]
    buffer_load_dwordx4 v[204:207], v234, s[44:47], s76 offen sc1
    s_cmp_eq_u32 s73, 36
    s_cselect_b32 s29, s75, 1024
    s_add_u32 s76, s76, s29
    ds_read_b64_tr_b16 v[32:33], v232 offset:18432
    ds_read_b64_tr_b16 v[34:35], v232 offset:19456
    ds_read_b64_tr_b16 v[36:37], v233 offset:18432
    ds_read_b64_tr_b16 v[38:39], v233 offset:19456
    s_waitcnt lgkmcnt(8)
    s_waitcnt vmcnt(9)
    v_mfma_f32_32x32x16_bf16 v[0:15], v[40:43], v[208:211], v[0:15]
    v_mfma_f32_32x32x16_bf16 v[16:31], v[44:47], v[208:211], v[16:31]
    buffer_load_dwordx4 v[208:211], v234, s[44:47], s76 offen sc1
    s_cmp_eq_u32 s73, 37
    s_cselect_b32 s29, s75, 1024
    s_add_u32 s76, s76, s29
    ds_read_b64_tr_b16 v[40:41], v232 offset:20480
    ds_read_b64_tr_b16 v[42:43], v232 offset:21504
    ds_read_b64_tr_b16 v[44:45], v233 offset:20480
    ds_read_b64_tr_b16 v[46:47], v233 offset:21504
    s_waitcnt lgkmcnt(8)
    s_waitcnt vmcnt(9)
    v_mfma_f32_32x32x16_bf16 v[0:15], v[48:51], v[212:215], v[0:15]
    v_mfma_f32_32x32x16_bf16 v[16:31], v[52:55], v[212:215], v[16:31]
    buffer_load_dwordx4 v[212:215], v234, s[44:47], s76 offen sc1
    s_cmp_eq_u32 s73, 38
    s_cselect_b32 s29, s75, 1024
    s_add_u32 s76, s76, s29
    ds_read_b64_tr_b16 v[48:49], v232 offset:22528
    ds_read_b64_tr_b16 v[50:51], v232 offset:23552
    ds_read_b64_tr_b16 v[52:53], v233 offset:22528
    ds_read_b64_tr_b16 v[54:55], v233 offset:23552
    s_waitcnt lgkmcnt(8)
    s_waitcnt vmcnt(9)
    v_mfma_f32_32x32x16_bf16 v[0:15], v[32:35], v[216:219], v[0:15]
    v_mfma_f32_32x32x16_bf16 v[16:31], v[36:39], v[216:219], v[16:31]
    ds_read_b64_tr_b16 v[32:33], v232 offset:24576
    ds_read_b64_tr_b16 v[34:35], v232 offset:25600
    ds_read_b64_tr_b16 v[36:37], v233 offset:24576
    ds_read_b64_tr_b16 v[38:39], v233 offset:25600
    s_waitcnt lgkmcnt(8)
    s_waitcnt vmcnt(8)
    v_mfma_f32_32x32x16_bf16 v[0:15], v[40:43], v[220:223], v[0:15]
    v_mfma_f32_32x32x16_bf16 v[16:31], v[44:47], v[220:223], v[16:31]
    ds_read_b64_tr_b16 v[40:41], v232 offset:26624
    ds_read_b64_tr_b16 v[42:43], v232 offset:27648
    ds_read_b64_tr_b16 v[44:45], v233 offset:26624
    ds_read_b64_tr_b16 v[46:47], v233 offset:27648
    s_waitcnt lgkmcnt(8)
    s_waitcnt vmcnt(7)
    v_mfma_f32_32x32x16_bf16 v[0:15], v[48:51], v[184:187], v[0:15]
    v_mfma_f32_32x32x16_bf16 v[16:31], v[52:55], v[184:187], v[16:31]
    ds_read_b64_tr_b16 v[48:49], v232 offset:28672
    ds_read_b64_tr_b16 v[50:51], v232 offset:29696
    ds_read_b64_tr_b16 v[52:53], v233 offset:28672
    ds_read_b64_tr_b16 v[54:55], v233 offset:29696
    s_waitcnt lgkmcnt(8)
    s_waitcnt vmcnt(6)
    v_mfma_f32_32x32x16_bf16 v[0:15], v[32:35], v[188:191], v[0:15]
    v_mfma_f32_32x32x16_bf16 v[16:31], v[36:39], v[188:191], v[16:31]
    ds_read_b64_tr_b16 v[32:33], v232 offset:30720
    ds_read_b64_tr_b16 v[34:35], v232 offset:31744
    ds_read_b64_tr_b16 v[36:37], v233 offset:30720
    ds_read_b64_tr_b16 v[38:39], v233 offset:31744
    s_waitcnt lgkmcnt(8)
    s_waitcnt vmcnt(5)
    v_mfma_f32_32x32x16_bf16 v[0:15], v[40:43], v[192:195], v[0:15]
    v_mfma_f32_32x32x16_bf16 v[16:31], v[44:47], v[192:195], v[16:31]
    ds_read_b64_tr_b16 v[40:41], v232 offset:32768
    ds_read_b64_tr_b16 v[42:43], v232 offset:33792
    ds_read_b64_tr_b16 v[44:45], v233 offset:32768
    ds_read_b64_tr_b16 v[46:47], v233 offset:33792
    s_waitcnt lgkmcnt(8)
    s_waitcnt vmcnt(4)
    v_mfma_f32_32x32x16_bf16 v[0:15], v[48:51], v[196:199], v[0:15]
    v_mfma_f32_32x32x16_bf16 v[16:31], v[52:55], v[196:199], v[16:31]
    ds_read_b64_tr_b16 v[48:49], v232 offset:34816
    ds_read_b64_tr_b16 v[50:51], v232 offset:35840
    ds_read_b64_tr_b16 v[52:53], v233 offset:34816
    ds_read_b64_tr_b16 v[54:55], v233 offset:35840
    s_waitcnt lgkmcnt(8)
    s_waitcnt vmcnt(3)
    v_mfma_f32_32x32x16_bf16 v[0:15], v[32:35], v[200:203], v[0:15]
    v_mfma_f32_32x32x16_bf16 v[16:31], v[36:39], v[200:203], v[16:31]
    ds_read_b64_tr_b16 v[32:33], v232 offset:36864
    ds_read_b64_tr_b16 v[34:35], v232 offset:37888
    ds_read_b64_tr_b16 v[36:37], v233 offset:36864
    ds_read_b64_tr_b16 v[38:39], v233 offset:37888
    s_waitcnt lgkmcnt(8)
    s_waitcnt vmcnt(2)
    v_mfma_f32_32x32x16_bf16 v[0:15], v[40:43], v[204:207], v[0:15]
    v_mfma_f32_32x32x16_bf16 v[16:31], v[44:47], v[204:207], v[16:31]
    s_waitcnt lgkmcnt(4)
    s_waitcnt vmcnt(1)
    v_mfma_f32_32x32x16_bf16 v[0:15], v[48:51], v[208:211], v[0:15]
    v_mfma_f32_32x32x16_bf16 v[16:31], v[52:55], v[208:211], v[16:31]
    s_waitcnt lgkmcnt(0)
    s_waitcnt vmcnt(0)
    v_mfma_f32_32x32x16_bf16 v[0:15], v[32:35], v[212:215], v[0:15]
    v_mfma_f32_32x32x16_bf16 v[16:31], v[36:39], v[212:215], v[16:31]
    s_branch L_g2_j_43
L_g2_s_42:
    s_mov_b32 m0, s37
    ds_read_b64_tr_b16 v[112:113], v232 offset:20480
    ds_read_b64_tr_b16 v[114:115], v232 offset:21504
    ds_read_b64_tr_b16 v[116:117], v233 offset:20480
    ds_read_b64_tr_b16 v[118:119], v233 offset:21504
    ds_read_b64_tr_b16 v[120:121], v232 offset:22528
    ds_read_b64_tr_b16 v[122:123], v232 offset:23552
    ds_read_b64_tr_b16 v[124:125], v233 offset:22528
    ds_read_b64_tr_b16 v[126:127], v233 offset:23552
    ds_read_b64_tr_b16 v[128:129], v232 offset:24576
    ds_read_b64_tr_b16 v[130:131], v232 offset:25600
    ds_read_b64_tr_b16 v[132:133], v233 offset:24576
    ds_read_b64_tr_b16 v[134:135], v233 offset:25600
    ds_read_b64_tr_b16 v[136:137], v232 offset:26624
    ds_read_b64_tr_b16 v[138:139], v232 offset:27648
    ds_read_b64_tr_b16 v[140:141], v233 offset:26624
    ds_read_b64_tr_b16 v[142:143], v233 offset:27648
    s_waitcnt lgkmcnt(12)
    ds_read_b64_tr_b16 v[144:145], v232 offset:28672
    ds_read_b64_tr_b16 v[146:147], v232 offset:29696
    ds_read_b64_tr_b16 v[148:149], v233 offset:28672
    ds_read_b64_tr_b16 v[150:151], v233 offset:29696
    s_waitcnt lgkmcnt(12)
    ds_read_b64_tr_b16 v[152:153], v232 offset:30720
    ds_read_b64_tr_b16 v[154:155], v232 offset:31744
    ds_read_b64_tr_b16 v[156:157], v233 offset:30720
    ds_read_b64_tr_b16 v[158:159], v233 offset:31744
    s_waitcnt lgkmcnt(12)
    ds_read_b64_tr_b16 v[160:161], v232 offset:32768
    ds_read_b64_tr_b16 v[162:163], v232 offset:33792
    ds_read_b64_tr_b16 v[164:165], v233 offset:32768
    ds_read_b64_tr_b16 v[166:167], v233 offset:33792
    s_waitcnt lgkmcnt(12)
    ds_read_b64_tr_b16 v[168:169], v232 offset:34816
    ds_read_b64_tr_b16 v[170:171], v232 offset:35840
    ds_read_b64_tr_b16 v[172:173], v233 offset:34816
    ds_read_b64_tr_b16 v[174:175], v233 offset:35840
    s_waitcnt lgkmcnt(12)
    ds_read_b64_tr_b16 v[176:177], v232 offset:36864
    ds_read_b64_tr_b16 v[178:179], v232 offset:37888
    ds_read_b64_tr_b16 v[180:181], v233 offset:36864
    ds_read_b64_tr_b16 v[182:183], v233 offset:37888
    s_waitcnt lgkmcnt(12)
    s_waitcnt lgkmcnt(0)
    s_barrier
    s_cmp_lg_u32 s24, 3
    s_cbranch_scc1 L_hwatch_48
    s_lshr_b32 s29, s70, 1
    s_add_u32 s29, s29, 16
    s_lshl_b32 s29, s29, 7
    s_add_u32 s29, s29, 86016
    v_mov_b32 v244, s29
    s_mov_b32 s31, 0
L_hwait_49:
    buffer_load_dword v245, v244, s[44:47], 0 offen sc1
    s_add_u32 s31, s31, 1
    s_waitcnt vmcnt(0)
    v_cmp_gt_u32 vcc, 14, v245
    s_nop 4
    s_cmp_gt_u32 s31, 400000
    s_cbranch_scc1 L_hwait_done_50
    s_cbranch_vccz L_hwait_done_50
    s_sleep 1
    s_branch L_hwait_49
L_hwait_done_50:
    v_mov_b32 v240, 155680
    v_mov_b32 v241, 1
    ds_write_b32 v240, v241
L_hwatch_48:
    buffer_load_dwordx4 v237, s[12:15], s38 offen lds
    s_add_u32 m0, m0, 2048
    s_add_u32 s38, s38, 14336
    buffer_load_dwordx4 v237, s[12:15], s38 offen lds
    s_add_u32 m0, m0, 2048
    s_add_u32 s38, s38, 14336
    s_sub_u32 s38, s38, s36
    buffer_load_dwordx4 v237, s[12:15], s38 offen lds
    s_add_u32 m0, m0, 2048
    s_add_u32 s38, s38, 14336
    buffer_load_dwordx4 v237, s[12:15], s38 offen lds
    s_add_u32 m0, m0, 2048
    s_add_u32 s38, s38, 14336
    s_sub_u32 s38, s38, s36
    buffer_load_dwordx4 v237, s[12:15], s38 offen lds
    s_add_u32 m0, m0, 2048
    s_add_u32 s38, s38, 14336
    buffer_load_dwordx4 v237, s[12:15], s38 offen lds
    s_add_u32 m0, m0, 2048
    s_add_u32 s38, s38, 14336
    s_sub_u32 s38, s38, s36
    buffer_load_dwordx4 v237, s[12:15], s38 offen lds
    s_add_u32 m0, m0, 2048
    s_add_u32 s38, s38, 14336
    buffer_load_dwordx4 v237, s[12:15], s38 offen lds
    s_add_u32 m0, m0, 2048
    s_add_u32 s38, s38, 14336
    s_sub_u32 s38, s38, s36
    buffer_load_dwordx4 v237, s[12:15], s38 offen lds
    s_add_u32 m0, m0, 2048
    s_add_u32 s38, s38, 14336
    buffer_load_dwordx4 v237, s[12:15], s38 offen lds
    s_add_u32 m0, m0, 2048
    s_add_u32 s38, s38, 14336
    s_sub_u32 s38, s38, s36
    buffer_load_dwordx4 v237, s[12:15], s38 offen lds
    s_add_u32 m0, m0, 2048
    s_add_u32 s38, s38, 14336
    buffer_load_dwordx4 v237, s[12:15], s38 offen lds
    s_add_u32 m0, m0, 2048
    s_add_u32 s38, s38, 14336
    s_sub_u32 s38, s38, s36
    buffer_load_dwordx4 v237, s[12:15], s38 offen lds
    s_add_u32 m0, m0, 2048
    s_add_u32 s38, s38, 14336
    buffer_load_dwordx4 v237, s[12:15], s38 offen lds
    s_add_u32 m0, m0, 2048
    s_add_u32 s38, s38, 14336
    s_sub_u32 s38, s38, s36
    s_sub_u32 s38, s38, s36
    buffer_load_dwordx4 v237, s[12:15], s38 offen lds
    s_add_u32 m0, m0, 2048
    s_add_u32 s38, s38, 14336
    buffer_load_dwordx4 v237, s[12:15], s38 offen lds
    s_add_u32 m0, m0, 2048
    s_add_u32 s38, s38, 14336
    s_sub_u32 s38, s38, s36
    buffer_load_dwordx2 v[228:229], v235, s[20:23], 0 offen
    buffer_load_dwordx2 v[230:231], v235, s[20:23], 0 offen offset:16
    s_lshr_b32 s29, s70, 1
    s_add_u32 s29, s29, 32
    s_lshl_b32 s29, s29, 7
    s_add_u32 s29, s29, 86016
    v_mov_b32 v244, s29
    s_mov_b32 s31, 0
L_owait_51:
    buffer_load_dword v245, v244, s[44:47], 0 offen sc1
    s_add_u32 s31, s31, 1
    s_waitcnt vmcnt(0)
    v_cmp_gt_u32 vcc, 2, v245
    s_nop 4
    s_cmp_gt_u32 s31, 400000
    s_cbranch_scc1 L_owait_done_52
    s_cbranch_vccz L_owait_done_52
    s_sleep 1
    s_branch L_owait_51
L_owait_done_52:
    buffer_load_dwordx4 v[184:187], v234, s[44:47], 0 offen offset:0 sc1
    buffer_load_dwordx4 v[188:191], v234, s[44:47], 0 offen offset:1024 sc1
    buffer_load_dwordx4 v[192:195], v234, s[44:47], 0 offen offset:2048 sc1
    buffer_load_dwordx4 v[196:199], v234, s[44:47], 0 offen offset:3072 sc1
    v_add_u32 v234, 4096, v234
    buffer_load_dwordx4 v[200:203], v234, s[44:47], 0 offen offset:0 sc1
    buffer_load_dwordx4 v[204:207], v234, s[44:47], 0 offen offset:1024 sc1
    buffer_load_dwordx4 v[208:211], v234, s[44:47], 0 offen offset:2048 sc1
    buffer_load_dwordx4 v[212:215], v234, s[44:47], 0 offen offset:3072 sc1
    v_add_u32 v234, 4096, v234
    buffer_load_dwordx4 v[216:219], v234, s[44:47], 0 offen offset:0 sc1
    buffer_load_dwordx4 v[220:223], v234, s[44:47], 0 offen offset:1024 sc1
    s_waitcnt vmcnt(9)
    v_mfma_f32_32x32x16_bf16 v[0:15], v[32:35], v[184:187], 0
    v_mfma_f32_32x32x16_bf16 v[16:31], v[36:39], v[184:187], 0
    buffer_load_dwordx4 v[184:187], v234, s[44:47], 0 offen offset:2048 sc1
    s_waitcnt vmcnt(9)
    v_mfma_f32_32x32x16_bf16 v[0:15], v[40:43], v[188:191], v[0:15]
    v_mfma_f32_32x32x16_bf16 v[16:31], v[44:47], v[188:191], v[16:31]
    buffer_load_dwordx4 v[188:191], v234, s[44:47], 0 offen offset:3072 sc1
    s_waitcnt vmcnt(9)
    v_mfma_f32_32x32x16_bf16 v[0:15], v[48:51], v[192:195], v[0:15]
    v_mfma_f32_32x32x16_bf16 v[16:31], v[52:55], v[192:195], v[16:31]
    v_add_u32 v234, 4096, v234
    buffer_load_dwordx4 v[192:195], v234, s[44:47], 0 offen offset:0 sc1
    s_waitcnt vmcnt(9)
    v_mfma_f32_32x32x16_bf16 v[0:15], v[56:59], v[196:199], v[0:15]
    v_mfma_f32_32x32x16_bf16 v[16:31], v[60:63], v[196:199], v[16:31]
    buffer_load_dwordx4 v[196:199], v234, s[44:47], 0 offen offset:1024 sc1
    s_waitcnt vmcnt(9)
    v_mfma_f32_32x32x16_bf16 v[0:15], v[64:67], v[200:203], v[0:15]
    v_mfma_f32_32x32x16_bf16 v[16:31], v[68:71], v[200:203], v[16:31]
    buffer_load_dwordx4 v[200:203], v234, s[44:47], 0 offen offset:2048 sc1
    s_waitcnt vmcnt(9)
    v_mfma_f32_32x32x16_bf16 v[0:15], v[72:75], v[204:207], v[0:15]
    v_mfma_f32_32x32x16_bf16 v[16:31], v[76:79], v[204:207], v[16:31]
    buffer_load_dwordx4 v[204:207], v234, s[44:47], 0 offen offset:3072 sc1
    s_waitcnt vmcnt(9)
    v_mfma_f32_32x32x16_bf16 v[0:15], v[80:83], v[208:211], v[0:15]
    v_mfma_f32_32x32x16_bf16 v[16:31], v[84:87], v[208:211], v[16:31]
    v_add_u32 v234, 4096, v234
    buffer_load_dwordx4 v[208:211], v234, s[44:47], 0 offen offset:0 sc1
    s_waitcnt vmcnt(9)
    v_mfma_f32_32x32x16_bf16 v[0:15], v[88:91], v[212:215], v[0:15]
    v_mfma_f32_32x32x16_bf16 v[16:31], v[92:95], v[212:215], v[16:31]
    buffer_load_dwordx4 v[212:215], v234, s[44:47], 0 offen offset:1024 sc1
    s_waitcnt vmcnt(9)
    v_mfma_f32_32x32x16_bf16 v[0:15], v[96:99], v[216:219], v[0:15]
    v_mfma_f32_32x32x16_bf16 v[16:31], v[100:103], v[216:219], v[16:31]
    buffer_load_dwordx4 v[216:219], v234, s[44:47], 0 offen offset:2048 sc1
    s_waitcnt vmcnt(9)
    v_mfma_f32_32x32x16_bf16 v[0:15], v[104:107], v[220:223], v[0:15]
    v_mfma_f32_32x32x16_bf16 v[16:31], v[108:111], v[220:223], v[16:31]
    buffer_load_dwordx4 v[220:223], v234, s[44:47], 0 offen offset:3072 sc1
    s_waitcnt vmcnt(9)
    v_mfma_f32_32x32x16_bf16 v[0:15], v[112:115], v[184:187], v[0:15]
    v_mfma_f32_32x32x16_bf16 v[16:31], v[116:119], v[184:187], v[16:31]
    v_add_u32 v234, 4096, v234
    buffer_load_dwordx4 v[184:187], v234, s[44:47], 0 offen offset:0 sc1
    s_waitcnt vmcnt(9)
    v_mfma_f32_32x32x16_bf16 v[0:15], v[120:123], v[188:191], v[0:15]
    v_mfma_f32_32x32x16_bf16 v[16:31], v[124:127], v[188:191], v[16:31]
    buffer_load_dwordx4 v[188:191], v234, s[44:47], 0 offen offset:1024 sc1
    s_waitcnt vmcnt(9)
    v_mfma_f32_32x32x16_bf16 v[0:15], v[128:131], v[192:195], v[0:15]
    v_mfma_f32_32x32x16_bf16 v[16:31], v[132:135], v[192:195], v[16:31]
    buffer_load_dwordx4 v[192:195], v234, s[44:47], 0 offen offset:2048 sc1
    s_waitcnt vmcnt(9)
    v_mfma_f32_32x32x16_bf16 v[0:15], v[136:139], v[196:199], v[0:15]
    v_mfma_f32_32x32x16_bf16 v[16:31], v[140:143], v[196:199], v[16:31]
    buffer_load_dwordx4 v[196:199], v234, s[44:47], 0 offen offset:3072 sc1
    s_waitcnt vmcnt(9)
    v_mfma_f32_32x32x16_bf16 v[0:15], v[144:147], v[200:203], v[0:15]
    v_mfma_f32_32x32x16_bf16 v[16:31], v[148:151], v[200:203], v[16:31]
    v_add_u32 v234, 4096, v234
    buffer_load_dwordx4 v[200:203], v234, s[44:47], 0 offen offset:0 sc1
    s_waitcnt vmcnt(9)
    v_mfma_f32_32x32x16_bf16 v[0:15], v[152:155], v[204:207], v[0:15]
    v_mfma_f32_32x32x16_bf16 v[16:31], v[156:159], v[204:207], v[16:31]
    buffer_load_dwordx4 v[204:207], v234, s[44:47], 0 offen offset:1024 sc1
    s_lshl_b32 s29, s24, 2
    s_add_u32 s29, s29, 155648
    v_mov_b32 v240, s29
    v_mov_b32 v241, 1
    ds_write_b32 v240, v241
    v_xor_b32 v240, 16, v240
    s_mov_b32 s31, 0
L_pair_53:
    ds_read_b32 v242, v240
    s_add_u32 s31, s31, 1
    s_waitcnt lgkmcnt(0)
    v_cmp_eq_u32 vcc, 0, v242
    s_cmp_gt_u32 s31, 3200000
    s_cbranch_scc1 L_pair_done_54
    s_nop 2
    s_cbranch_vccnz L_pair_53
L_pair_done_54:
    ds_read_b64_tr_b16 v[32:33], v232 offset:0
    ds_read_b64_tr_b16 v[34:35], v232 offset:1024
    ds_read_b64_tr_b16 v[36:37], v233 offset:0
    ds_read_b64_tr_b16 v[38:39], v233 offset:1024
    ds_read_b64_tr_b16 v[40:41], v232 offset:2048
    ds_read_b64_tr_b16 v[42:43], v232 offset:3072
    ds_read_b64_tr_b16 v[44:45], v233 offset:2048
    ds_read_b64_tr_b16 v[46:47], v233 offset:3072
    ds_read_b64_tr_b16 v[48:49], v232 offset:4096
    ds_read_b64_tr_b16 v[50:51], v232 offset:5120
    ds_read_b64_tr_b16 v[52:53], v233 offset:4096
    ds_read_b64_tr_b16 v[54:55], v233 offset:5120
    s_waitcnt lgkmcnt(8)
    s_waitcnt vmcnt(9)
    v_mfma_f32_32x32x16_bf16 v[0:15], v[32:35], v[208:211], v[0:15]
    v_mfma_f32_32x32x16_bf16 v[16:31], v[36:39], v[208:211], v[16:31]
    buffer_load_dwordx4 v[208:211], v234, s[44:47], 0 offen offset:2048 sc1
    ds_read_b64_tr_b16 v[32:33], v232 offset:6144
    ds_read_b64_tr_b16 v[34:35], v232 offset:7168
    ds_read_b64_tr_b16 v[36:37], v233 offset:6144
    ds_read_b64_tr_b16 v[38:39], v233 offset:7168
    s_waitcnt lgkmcnt(8)
    s_waitcnt vmcnt(9)
    v_mfma_f32_32x32x16_bf16 v[0:15], v[40:43], v[212:215], v[0:15]
    v_mfma_f32_32x32x16_bf16 v[16:31], v[44:47], v[212:215], v[16:31]
    buffer_load_dwordx4 v[212:215], v234, s[44:47], 0 offen offset:3072 sc1
    ds_read_b64_tr_b16 v[40:41], v232 offset:8192
    ds_read_b64_tr_b16 v[42:43], v232 offset:9216
    ds_read_b64_tr_b16 v[44:45], v233 offset:8192
    ds_read_b64_tr_b16 v[46:47], v233 offset:9216
    s_waitcnt lgkmcnt(8)
    s_waitcnt vmcnt(9)
    v_mfma_f32_32x32x16_bf16 v[0:15], v[48:51], v[216:219], v[0:15]
    v_mfma_f32_32x32x16_bf16 v[16:31], v[52:55], v[216:219], v[16:31]
    v_add_u32 v234, 4096, v234
    buffer_load_dwordx4 v[216:219], v234, s[44:47], 0 offen offset:0 sc1
    ds_read_b64_tr_b16 v[48:49], v232 offset:10240
    ds_read_b64_tr_b16 v[50:51], v232 offset:11264
    ds_read_b64_tr_b16 v[52:53], v233 offset:10240
    ds_read_b64_tr_b16 v[54:55], v233 offset:11264
    s_waitcnt lgkmcnt(8)
    s_waitcnt vmcnt(9)
    v_mfma_f32_32x32x16_bf16 v[0:15], v[32:35], v[220:223], v[0:15]
    v_mfma_f32_32x32x16_bf16 v[16:31], v[36:39], v[220:223], v[16:31]
    buffer_load_dwordx4 v[220:223], v234, s[44:47], 0 offen offset:1024 sc1
    ds_read_b64_tr_b16 v[32:33], v232 offset:12288
    ds_read_b64_tr_b16 v[34:35], v232 offset:13312
    ds_read_b64_tr_b16 v[36:37], v233 offset:12288
    ds_read_b64_tr_b16 v[38:39], v233 offset:13312
    s_waitcnt lgkmcnt(8)
    s_waitcnt vmcnt(9)
    v_mfma_f32_32x32x16_bf16 v[0:15], v[40:43], v[184:187], v[0:15]
    v_mfma_f32_32x32x16_bf16 v[16:31], v[44:47], v[184:187], v[16:31]
    buffer_load_dwordx4 v[184:187], v234, s[44:47], 0 offen offset:2048 sc1
    ds_read_b64_tr_b16 v[40:41], v232 offset:14336
    ds_read_b64_tr_b16 v[42:43], v232 offset:15360
    ds_read_b64_tr_b16 v[44:45], v233 offset:14336
    ds_read_b64_tr_b16 v[46:47], v233 offset:15360
    s_waitcnt lgkmcnt(8)
    s_waitcnt vmcnt(9)
    v_mfma_f32_32x32x16_bf16 v[0:15], v[48:51], v[188:191], v[0:15]
    v_mfma_f32_32x32x16_bf16 v[16:31], v[52:55], v[188:191], v[16:31]
    buffer_load_dwordx4 v[188:191], v234, s[44:47], 0 offen offset:3072 sc1
    ds_read_b64_tr_b16 v[48:49], v232 offset:16384
    ds_read_b64_tr_b16 v[50:51], v232 offset:17408
    ds_read_b64_tr_b16 v[52:53], v233 offset:16384
    ds_read_b64_tr_b16 v[54:55], v233 offset:17408
    s_waitcnt lgkmcnt(8)
    s_waitcnt vmcnt(9)
    v_mfma_f32_32x32x16_bf16 v[0:15], v[32:35], v[192:195], v[0:15]
    v_mfma_f32_32x32x16_bf16 v[16:31], v[36:39], v[192:195], v[16:31]
    ds_read_b64_tr_b16 v[32:33], v232 offset:18432
    ds_read_b64_tr_b16 v[34:35], v232 offset:19456
    ds_read_b64_tr_b16 v[36:37], v233 offset:18432
    ds_read_b64_tr_b16 v[38:39], v233 offset:19456
    s_waitcnt lgkmcnt(8)
    s_waitcnt vmcnt(8)
    v_mfma_f32_32x32x16_bf16 v[0:15], v[40:43], v[196:199], v[0:15]
    v_mfma_f32_32x32x16_bf16 v[16:31], v[44:47], v[196:199], v[16:31]
    ds_read_b64_tr_b16 v[40:41], v232 offset:20480
    ds_read_b64_tr_b16 v[42:43], v232 offset:21504
    ds_read_b64_tr_b16 v[44:45], v233 offset:20480
    ds_read_b64_tr_b16 v[46:47], v233 offset:21504
    s_waitcnt lgkmcnt(8)
    s_waitcnt vmcnt(7)
    v_mfma_f32_32x32x16_bf16 v[0:15], v[48:51], v[200:203], v[0:15]
    v_mfma_f32_32x32x16_bf16 v[16:31], v[52:55], v[200:203], v[16:31]
    ds_read_b64_tr_b16 v[48:49], v232 offset:22528
    ds_read_b64_tr_b16 v[50:51], v232 offset:23552
    ds_read_b64_tr_b16 v[52:53], v233 offset:22528
    ds_read_b64_tr_b16 v[54:55], v233 offset:23552
    s_waitcnt lgkmcnt(8)
    s_waitcnt vmcnt(6)
    v_mfma_f32_32x32x16_bf16 v[0:15], v[32:35], v[204:207], v[0:15]
    v_mfma_f32_32x32x16_bf16 v[16:31], v[36:39], v[204:207], v[16:31]
    ds_read_b64_tr_b16 v[32:33], v232 offset:24576
    ds_read_b64_tr_b16 v[34:35], v232 offset:25600
    ds_read_b64_tr_b16 v[36:37], v233 offset:24576
    ds_read_b64_tr_b16 v[38:39], v233 offset:25600
    s_waitcnt lgkmcnt(8)
    s_waitcnt vmcnt(5)
    v_mfma_f32_32x32x16_bf16 v[0:15], v[40:43], v[208:211], v[0:15]
    v_mfma_f32_32x32x16_bf16 v[16:31], v[44:47], v[208:211], v[16:31]
    ds_read_b64_tr_b16 v[40:41], v232 offset:26624
    ds_read_b64_tr_b16 v[42:43], v232 offset:27648
    ds_read_b64_tr_b16 v[44:45], v233 offset:26624
    ds_read_b64_tr_b16 v[46:47], v233 offset:27648
    s_waitcnt lgkmcnt(8)
    s_waitcnt vmcnt(4)
    v_mfma_f32_32x32x16_bf16 v[0:15], v[48:51], v[212:215], v[0:15]
    v_mfma_f32_32x32x16_bf16 v[16:31], v[52:55], v[212:215], v[16:31]
    ds_read_b64_tr_b16 v[48:49], v232 offset:28672
    ds_read_b64_tr_b16 v[50:51], v232 offset:29696
    ds_read_b64_tr_b16 v[52:53], v233 offset:28672
    ds_read_b64_tr_b16 v[54:55], v233 offset:29696
    s_waitcnt lgkmcnt(8)
    s_waitcnt vmcnt(3)
    v_mfma_f32_32x32x16_bf16 v[0:15], v[32:35], v[216:219], v[0:15]
    v_mfma_f32_32x32x16_bf16 v[16:31], v[36:39], v[216:219], v[16:31]
    ds_read_b64_tr_b16 v[32:33], v232 offset:30720
    ds_read_b64_tr_b16 v[34:35], v232 offset:31744
    ds_read_b64_tr_b16 v[36:37], v233 offset:30720
    ds_read_b64_tr_b16 v[38:39], v233 offset:31744
    s_waitcnt lgkmcnt(8)
    s_waitcnt vmcnt(2)
    v_mfma_f32_32x32x16_bf16 v[0:15], v[40:43], v[220:223], v[0:15]
    v_mfma_f32_32x32x16_bf16 v[16:31], v[44:47], v[220:223], v[16:31]
    s_waitcnt lgkmcnt(4)
    s_waitcnt vmcnt(1)
    v_mfma_f32_32x32x16_bf16 v[0:15], v[48:51], v[184:187], v[0:15]
    v_mfma_f32_32x32x16_bf16 v[16:31], v[52:55], v[184:187], v[16:31]
    s_waitcnt lgkmcnt(0)
    s_waitcnt vmcnt(0)
    v_mfma_f32_32x32x16_bf16 v[0:15], v[32:35], v[188:191], v[0:15]
    v_mfma_f32_32x32x16_bf16 v[16:31], v[36:39], v[188:191], v[16:31]
L_g2_j_43:
    s_barrier
    s_lshl_b32 s29, s26, 11
    v_add_u32 v240, s29, v236
    s_lshl_b32 s29, s26, 13
    v_add_u32 v241, s29, v236
    s_waitcnt vmcnt(0)
    v_lshlrev_b32 v96, 16, v228
    v_and_b32 v97, s3, v228
    v_lshlrev_b32 v98, 16, v229
    v_and_b32 v99, s3, v229
    v_lshlrev_b32 v100, 16, v230
    v_and_b32 v101, s3, v230
    v_lshlrev_b32 v102, 16, v231
    v_and_b32 v103, s3, v231
    ds_write_b128 v240, v[0:3] offset:0
    ds_write_b128 v240, v[4:7] offset:1024
    ds_write_b128 v240, v[8:11] offset:8192
    ds_write_b128 v240, v[12:15] offset:9216
    ds_write_b128 v240, v[16:19] offset:16384
    ds_write_b128 v240, v[20:23] offset:17408
    ds_write_b128 v240, v[24:27] offset:24576
    ds_write_b128 v240, v[28:31] offset:25600
    v_lshrrev_b32 v242, 5, v226
    v_lshl_add_u32 v242, v242, 3, v235
    s_mov_b32 s29, 3216550459
    s_waitcnt lgkmcnt(0)
    s_barrier
    ds_read_b128 v[32:35], v241 offset:0
    ds_read_b128 v[36:39], v241 offset:1024
    ds_read_b128 v[40:43], v241 offset:2048
    ds_read_b128 v[44:47], v241 offset:3072
    ds_read_b128 v[48:51], v241 offset:4096
    ds_read_b128 v[52:55], v241 offset:5120
    ds_read_b128 v[56:59], v241 offset:6144
    ds_read_b128 v[60:63], v241 offset:7168
    s_mov_b32 s28, s29
    s_mov_b32 s30, 1.0
    s_mov_b32 s31, 1.0
    s_waitcnt lgkmcnt(4)
    v_pk_add_f32 v[80:81], v[32:33], v[40:41]
    v_pk_add_f32 v[82:83], v[34:35], v[42:43]
    v_pk_add_f32 v[84:85], v[36:37], v[44:45]
    v_pk_add_f32 v[86:87], v[38:39], v[46:47]
    s_waitcnt lgkmcnt(2)
    v_pk_add_f32 v[80:81], v[80:81], v[48:49]
    v_pk_add_f32 v[82:83], v[82:83], v[50:51]
    v_pk_add_f32 v[84:85], v[84:85], v[52:53]
    v_pk_add_f32 v[86:87], v[86:87], v[54:55]
    v_pk_mul_f32 v[88:89], v[80:81], s[28:29]
    v_pk_mul_f32 v[90:91], v[82:83], s[28:29]
    v_pk_mul_f32 v[92:93], v[84:85], s[28:29]
    v_pk_mul_f32 v[94:95], v[86:87], s[28:29]
    v_exp_f32 v88, v88
    v_exp_f32 v89, v89
    v_exp_f32 v90, v90
    v_exp_f32 v91, v91
    v_exp_f32 v92, v92
    v_exp_f32 v93, v93
    v_exp_f32 v94, v94
    v_exp_f32 v95, v95
    s_waitcnt lgkmcnt(0)
    v_pk_mul_f32 v[80:81], v[80:81], v[56:57]
    v_pk_mul_f32 v[82:83], v[82:83], v[58:59]
    v_pk_mul_f32 v[84:85], v[84:85], v[60:61]
    v_pk_mul_f32 v[86:87], v[86:87], v[62:63]
    v_pk_add_f32 v[88:89], v[88:89], s[30:31]
    v_pk_add_f32 v[90:91], v[90:91], s[30:31]
    v_pk_add_f32 v[92:93], v[92:93], s[30:31]
    v_pk_add_f32 v[94:95], v[94:95], s[30:31]
    v_rcp_f32 v88, v88
    v_rcp_f32 v89, v89
    v_rcp_f32 v90, v90
    v_rcp_f32 v91, v91
    v_rcp_f32 v92, v92
    v_rcp_f32 v93, v93
    v_rcp_f32 v94, v94
    v_rcp_f32 v95, v95
    s_nop 0
    v_pk_fma_f32 v[80:81], v[80:81], v[88:89], v[96:97]
    v_pk_fma_f32 v[82:83], v[82:83], v[90:91], v[98:99]
    v_pk_fma_f32 v[84:85], v[84:85], v[92:93], v[100:101]
    v_pk_fma_f32 v[86:87], v[86:87], v[94:95], v[102:103]
    v_cvt_pk_bf16_f32 v104, v80, v81
    v_cvt_pk_bf16_f32 v105, v82, v83
    v_cvt_pk_bf16_f32 v106, v84, v85
    v_cvt_pk_bf16_f32 v107, v86, v87
    s_nop 1
    v_permlane32_swap_b32 v104, v106
    v_permlane32_swap_b32 v105, v107
    buffer_store_dwordx4 v[104:107], v242, s[16:19], 0 offen
    s_endpgm
L_end:
    s_endpgm

.section .rodata,"a"
.p2align 6
.amdhsa_kernel recurrent_scan__linear_attn_block__swiglu_ffn__prompt_kernel
  .amdhsa_next_free_vgpr 256
  .amdhsa_next_free_sgpr 102
  .amdhsa_accum_offset 256
  .amdhsa_group_segment_fixed_size 0
  .amdhsa_kernarg_size 80
  .amdhsa_user_sgpr_count 2
  .amdhsa_user_sgpr_kernarg_segment_ptr 1
  .amdhsa_system_sgpr_workgroup_id_x 1
.end_amdhsa_kernel
```
